```python
import torch

def _softmax(x, axis=-1):
    return torch.softmax(x, dim=axis)
def _gelu(x):
    return torch.nn.functional.gelu(x, approximate="tanh")
def _silu(x):
    return torch.nn.functional.silu(x)
def _sigmoid(x):
    return torch.sigmoid(x)
def _layernorm(x, axis=-1, eps=1e-5):
    m = x.mean(dim=axis, keepdim=True)
    v = x.var(dim=axis, keepdim=True, unbiased=False)
    return (x - m) / torch.sqrt(v + eps)
def _scatter_add(tgt, idx, src, axis=0):
    return tgt.clone().index_add_(axis, idx, src)
def _segment_sum(src, seg, n):
    out = torch.zeros((n,) + src.shape[1:], dtype=src.dtype)
    return out.index_add_(0, seg, src)
def _pad(x, pw):
    flat = tuple(v for pair in reversed(pw) for v in pair)
    return torch.nn.functional.pad(x, flat)

kernel_name = 'standalone__modern_conv_block_convnext__vision'

def setup_inputs():

    _w = (lambda a: (lambda t: t.to(torch.bfloat16) if t.is_floating_point() else t)(torch.as_tensor(a)))
    H = W = 224
    C = 96
    K = 5
    return {
        "x": _w((lambda *s: torch.randn(*s, dtype=torch.bfloat16) * 0.05)(1, H, W, C)),
        "dw": _w((lambda *s: torch.randn(*s, dtype=torch.bfloat16) * 0.05)(K, K, C)),
        "w1": _w((lambda *s: torch.randn(*s, dtype=torch.bfloat16) * 0.05)(C, 4 * C)),
        "b1": _w((lambda *s: torch.randn(*s, dtype=torch.bfloat16) * 0.2)(4 * C)),
        "w2": _w((lambda *s: torch.randn(*s, dtype=torch.bfloat16) * 0.05)(4 * C, C)),
        "b2": _w((lambda *s: torch.randn(*s, dtype=torch.bfloat16) * 0.4)(C)),
        "gamma": _w((lambda *s: torch.randn(*s, dtype=torch.bfloat16) * 0.05)(C)),
    }

def reference(x, dw, w1, b1, w2, b2, gamma):
    B, H, W, C = x.shape
    K = dw.shape[0]
    pad = K // 2
    xp = _pad(x, ((0,0),(pad,pad),(pad,pad),(0,0)))
    out = torch.zeros_like(x)
    for i in range(K):
        for j in range(K):
            out = out + xp[:, i:i+H, j:j+W, :] * dw[i, j][None, None, None, :]
    h = _layernorm(out, axis=-1)
    h = torch.einsum('bhwc,ce->bhwe', h, w1) + b1
    h = _gelu(h)
    h = torch.einsum('bhwe,ec->bhwc', h, w2) + b2
    return x + gamma[None, None, None, :] * h
```

```asm
; @launch grid=(224,1,1) block=(512,1,1) lds=162112
.amdgcn_target "amdgcn-amd-amdhsa--gfx950"
.text
.globl standalone__modern_conv_block_convnext__vision_kernel
.p2align 8
.type standalone__modern_conv_block_convnext__vision_kernel,@function
standalone__modern_conv_block_convnext__vision_kernel:
    s_branch L_start
L_pf:
    s_getpc_b64 s[14:15]
L_pc:
    v_subrev_u32 v224, 448, v0
    s_mul_i32 s56, s56, 8192
    v_lshl_add_u32 v224, v224, 7, s56
    v_min_u32 v224, L_codeend-standalone__modern_conv_block_convnext__vision_kernel-4, v224
    s_sub_u32 s14, s14, L_pc-standalone__modern_conv_block_convnext__vision_kernel
    s_subb_u32 s15, s15, 0
    global_load_dword v224, v224, s[14:15]
    s_branch L_pfdone
L_start:
    s_load_dwordx2 s[24:25], s[0:1], 0
    v_readfirstlane_b32 s48, v0
    s_lshr_b32 s56, s2, 3
    s_cmp_ge_u32 s48, 448
    s_cselect_b32 s55, s56, 63
    s_cmp_lt_u32 s55, 6
    s_cbranch_scc1 L_pf
L_pfdone:
    s_and_b32 s54, s2, 7
    s_lshr_b32 s55, s2, 3
    s_mul_i32 s54, s54, 28
    s_cmp_ge_u32 s2, 224
    s_cbranch_scc1 L_end
    s_add_u32 s54, s54, s55
    s_lshr_b32 s48, s48, 6
    v_and_b32 v0, 63, v0
    s_mul_hi_u32 s50, s54, 0x12492493
    s_and_b32 s49, s48, 3
    s_mul_i32 s55, s50, 14
    s_sub_u32 s51, s54, s55
    s_cmp_lt_u32 s48, 4
    s_cbranch_scc0 L_issueL
    s_setprio 3
    s_load_dwordx2 s[28:29], s[0:1], 8
    s_load_dwordx2 s[4:5], s[0:1], 24
    s_load_dwordx2 s[6:7], s[0:1], 40
    s_load_dwordx2 s[8:9], s[0:1], 48
    v_lshlrev_b32 v9, 4, v0
    s_lshl_b32 s55, s49, 11
    s_sub_u32 s56, s55, 960
    v_add_u32 v239, s56, v9
    v_add_u32 v240, 0x400, v239
    s_add_u32 s58, s55, 147456
    s_mov_b32 s30, 4800
    s_mov_b32 s31, 0x20000
    v_mul_u32_u24 v236, 43, v0
    s_mul_i32 s55, s49, 5
    v_lshrrev_b32 v236, 9, v236
    v_mul_u32_u24 v237, 12, v236
    v_add_u32 v236, s55, v236
    v_sub_u32 v237, v0, v237
    s_lshl_b32 s55, s51, 4
    v_bfe_u32 v238, v236, 2, 2
    s_sub_u32 s55, s55, 2
    v_xor_b32 v237, v237, v238
    v_add_u32 v236, s55, v236
    v_min_u32 v236, 0xe0, v236
    v_add_u32 v238, 32, v236
    v_lshrrev_b32 v238, 8, v238
    v_mul_u32_u24 v236, 0xc0, v236
    v_lshl_add_u32 v236, v237, 4, v236
    v_lshl_add_u32 v1, v238, 29, v236
    s_mul_i32 s52, s50, 602112
    s_bitcmp0_b32 s50, 0
    s_cselect_b32 s62, 1, 0
    s_mov_b32 s59, 43008
    s_cmov_b32 s59, -43008
    s_mov_b32 s54, -86016
    s_cmov_b32 s54, 645120
    s_add_u32 s52, s52, s54
    s_mul_i32 s53, s49, 960
    s_add_u32 s53, s53, 73728
    s_mov_b32 s26, 9633792
    s_mov_b32 s27, 0x20000
    s_mov_b32 s19, 0x20000
    s_cmp_lt_u32 s49, 2
    s_movk_i32 s18, 192
    s_cmov_b32 s18, 768
    s_cselect_b32 s56, s49, 0
    s_lshl_b32 s56, s56, 9
    v_lshl_add_u32 v230, v0, 3, s56
    s_mul_i32 s56, s62, 1920
    v_add_u32 v236, 960, v239
    v_mul_u32_u24 v236, 1093, v236
    v_lshrrev_b32 v236, 20, v236
    v_sub_u32 v236, 3, v236
    v_mad_i32_i24 v239, v236, s56, v239
    v_add_u32 v236, 960, v240
    v_mul_u32_u24 v236, 1093, v236
    v_lshrrev_b32 v236, 20, v236
    v_sub_u32 v236, 3, v236
    v_mad_i32_i24 v240, v236, s56, v240
    s_waitcnt lgkmcnt(0)
    s_mov_b32 m0, s58
    s_cmp_eq_u32 s49, 2
    buffer_load_dwordx4 v239, s[28:31], 0 offen lds
    s_cselect_b64 s[16:17], s[6:7], s[4:5]
    s_add_u32 m0, m0, 0x400
    s_cmp_eq_u32 s49, 3
    buffer_load_dwordx4 v240, s[28:31], 0 offen lds
    s_cselect_b64 s[16:17], s[8:9], s[16:17]
    s_mov_b32 s63, 0xbeeff558
    s_cmov_b32 s63, 0xc0088e99
    buffer_load_dwordx2 v[228:229], v230, s[16:19], 0 offen
    s_bfm_b64 exec, 60, 0
    s_load_dwordx2 s[32:33], s[0:1], 16
    s_load_dwordx2 s[36:37], s[0:1], 32
    s_load_dwordx2 s[40:41], s[0:1], 56
    s_add_u32 m0, s53, 0
    s_nop 0
    buffer_load_dwordx4 v1, s[24:27], s52 offen nt lds
    s_add_u32 m0, s53, 3840
    s_add_u32 s52, s52, s59
    buffer_load_dwordx4 v1, s[24:27], s52 offen nt lds
    s_add_u32 m0, s53, 7680
    s_add_u32 s52, s52, s59
    buffer_load_dwordx4 v1, s[24:27], s52 offen nt lds
    s_add_u32 m0, s53, 11520
    s_add_u32 s52, s52, s59
    buffer_load_dwordx4 v1, s[24:27], s52 offen nt lds
    s_add_u32 m0, s53, 15360
    s_add_u32 s52, s52, s59
    buffer_load_dwordx4 v1, s[24:27], s52 offen nt lds
    s_add_u32 m0, s53, 19200
    s_add_u32 s52, s52, s59
    buffer_load_dwordx4 v1, s[24:27], s52 offen nt lds
    s_add_u32 m0, s53, 23040
    s_add_u32 s52, s52, s59
    buffer_load_dwordx4 v1, s[24:27], s52 offen nt lds
    s_add_u32 m0, s53, 26880
    s_add_u32 s52, s52, s59
    buffer_load_dwordx4 v1, s[24:27], s52 offen nt lds
    s_add_u32 m0, s53, 30720
    s_add_u32 s52, s52, s59
    buffer_load_dwordx4 v1, s[24:27], s52 offen nt lds
    s_add_u32 m0, s53, 34560
    s_add_u32 s52, s52, s59
    buffer_load_dwordx4 v1, s[24:27], s52 offen nt lds
    s_add_u32 m0, s53, 38400
    s_add_u32 s52, s52, s59
    buffer_load_dwordx4 v1, s[24:27], s52 offen nt lds
    s_add_u32 m0, s53, 42240
    s_add_u32 s52, s52, s59
    buffer_load_dwordx4 v1, s[24:27], s52 offen nt lds
    s_mov_b64 exec, -1
    v_mov_b32 v15, 162048
    v_mov_b32 v3, 0
    v_add_u32 v14, s48, v15
    ds_write_b8 v14, v3
    ds_write_b8 v14, v3 offset:4
    v_and_b32 v241, 15, v0
    v_lshrrev_b32 v242, 4, v0
    v_lshrrev_b32 v243, 5, v0
    v_and_b32 v244, 1, v242
    v_bfe_u32 v245, v0, 2, 2
    v_and_b32 v246, 3, v0
    v_bfe_u32 v247, v0, 2, 3
    v_mul_u32_u24 v247, 0x300, v247
    v_lshl_add_u32 v247, v243, 6, v247
    v_lshl_add_u32 v2, v246, 4, v247
    s_mul_i32 s61, s49, 3072
    s_mul_i32 s60, s49, 18432
    s_mov_b32 s34, 73728
    s_mov_b32 s35, 0x20000
    s_mov_b32 s42, 9633792
    s_mov_b32 s43, 0x20000
    v_mul_u32_u24 v3, 0x5555, v246
    v_and_b32 v247, 2, v246
    v_and_b32 v248, 1, v246
    v_mul_u32_u24 v248, 960, v248
    v_lshlrev_b32 v247, 2, v247
    v_lshl_add_u32 v247, v245, 4, v247
    v_sub_u32 v247, v247, v248
    v_add_u32 v247, 148416, v247
    v_lshlrev_b32 v249, 3, v242
    s_movk_i32 s55, 0xc0
    s_mov_b32 s54, 201982464
    v_bfe_u32 v220, s54, v249, 8
    v_mad_u32_u24 v220, v220, s55, v247
    s_mov_b32 s54, 50402836
    v_bfe_u32 v221, s54, v249, 8
    v_mad_u32_u24 v221, v221, s55, v247
    s_mov_b32 s54, 387255563
    v_bfe_u32 v222, s54, v249, 8
    v_mad_u32_u24 v222, v222, s55, v247
    s_mov_b32 s54, 504892932
    v_bfe_u32 v223, s54, v249, 8
    v_mad_u32_u24 v223, v223, s55, v247
    v_bfe_i32 v247, v0, 3, 1
    v_lshrrev_b32 v226, 16, v247
    v_and_b32 v227, 0xffff0000, v247
    v_xor_b32 v224, 0xffff, v226
    v_xor_b32 v225, 0xffff0000, v227
    s_mul_i32 s55, s49, 7680
    s_add_u32 s55, s55, 73728
    v_lshl_add_u32 v249, v243, 1, v241
    v_bfe_u32 v247, v249, 2, 2
    v_mul_u32_u24 v248, 0xc0, v249
    v_lshl_add_u32 v247, v247, 4, v248
    v_mul_u32_u24 v248, 0xf00, v244
    v_add3_u32 v252, v247, v248, s55
    v_add_u32 v249, 1, v249
    v_bfe_u32 v247, v249, 2, 2
    v_mul_u32_u24 v248, 0xc0, v249
    v_lshl_add_u32 v247, v247, 4, v248
    v_mul_u32_u24 v248, 0xf00, v244
    v_add3_u32 v253, v247, v248, s55
    v_add_u32 v249, 4, v241
    v_bfe_u32 v247, v249, 2, 2
    v_mul_u32_u24 v248, 0xc0, v249
    v_lshl_add_u32 v247, v247, 4, v248
    v_mul_u32_u24 v248, 0xf00, v242
    v_add3_u32 v254, v247, v248, s55
    v_mul_u32_u24 v248, 7680, v243
    v_sub_u32 v248, v254, v248
    v_add_u32 v255, 15360, v248
    s_mul_i32 s55, s48, 7680
    s_add_u32 s55, s55, 81408
    v_add_u32 v249, 2, v241
    v_bfe_u32 v247, v249, 2, 2
    v_xor_b32 v247, v243, v247
    v_mul_u32_u24 v248, 0xc0, v249
    v_lshl_add_u32 v247, v247, 4, v248
    v_mul_u32_u24 v248, 0xf00, v244
    v_add3_u32 v7, v247, v248, s55
    v_lshl_add_u32 v247, v243, 2, v245
    v_lshlrev_b32 v248, 5, v244
    v_lshl_add_u32 v249, v246, 3, v248
    v_lshl_add_u32 v4, v247, 6, v249
    v_mul_u32_u24 v247, 0xc0, v247
    v_and_b32 v249, 1, v246
    v_lshl_add_u32 v248, v249, 4, v248
    v_lshrrev_b32 v249, 1, v246
    v_lshl_add_u32 v248, v249, 3, v248
    v_add_u32 v5, v247, v248
    v_lshlrev_b32 v247, 4, v243
    v_add_u32 v6, 159744, v247
    v_add_u32 v13, v6, v247
    s_mul_i32 s10, s49, 6144
    s_cmp_lt_u32 s49, 2
    s_cselect_b32 s54, 0, 12288
    s_add_u32 s10, s10, s54
    s_add_u32 s10, s10, 61440
    v_bfe_u32 v247, v241, 1, 2
    v_xor_b32 v247, v247, v243
    v_and_b32 v248, 31, v0
    v_mul_u32_u24 v248, 0xc0, v248
    v_lshl_add_u32 v247, v247, 4, v248
    v_add_u32 v8, s10, v247
    v_add_u32 v247, 0, v0
    v_mul_u32_u24 v248, 171, v247
    v_bfe_u32 v248, v248, 12, 2
    v_xor_b32 v247, v247, v248
    v_lshlrev_b32 v10, 4, v247
    v_add_u32 v247, 64, v0
    v_mul_u32_u24 v248, 171, v247
    v_bfe_u32 v248, v248, 12, 2
    v_xor_b32 v247, v247, v248
    v_lshlrev_b32 v11, 4, v247
    v_add_u32 v247, 128, v0
    v_mul_u32_u24 v248, 171, v247
    v_bfe_u32 v248, v248, 12, 2
    v_xor_b32 v247, v247, v248
    v_lshlrev_b32 v12, 4, v247
    s_mul_i32 s54, s50, 14
    s_mul_i32 s55, s62, 13
    s_add_u32 s54, s54, s55
    s_mul_i32 s54, s54, 43008
    s_lshl_b32 s55, s48, 1
    s_mul_i32 s55, s55, s59
    s_add_u32 s54, s54, s55
    s_mul_i32 s55, s51, 3072
    s_add_u32 s57, s54, s55
    v_mov_b32 v16, 0
    v_mov_b32 v17, 0
    v_mov_b32 v18, 0
    v_mov_b32 v19, 0
    v_mov_b32 v20, 0
    v_mov_b32 v21, 0
    v_mov_b32 v22, 0
    v_mov_b32 v23, 0
    v_mov_b32 v24, 0
    v_mov_b32 v25, 0
    v_mov_b32 v26, 0
    v_mov_b32 v27, 0
    s_waitcnt vmcnt(13) lgkmcnt(0)
    s_barrier
    ds_read_b64_tr_b16 v[124:125], v220 offset:0
    ds_read_b64_tr_b16 v[126:127], v220 offset:960
    ds_read_b64_tr_b16 v[128:129], v221 offset:0
    ds_read_b64_tr_b16 v[130:131], v221 offset:960
    ds_read_b64_tr_b16 v[132:133], v222 offset:0
    ds_read_b64_tr_b16 v[134:135], v222 offset:960
    ds_read_b64_tr_b16 v[136:137], v223 offset:0
    ds_read_b64_tr_b16 v[138:139], v223 offset:960
    ds_read_b64_tr_b16 v[140:141], v220 offset:64
    ds_read_b64_tr_b16 v[142:143], v220 offset:1024
    ds_read_b64_tr_b16 v[144:145], v221 offset:64
    ds_read_b64_tr_b16 v[146:147], v221 offset:1024
    s_lshl_b32 s54, s49, 10
    s_movk_i32 s55, 24
    s_cmp_eq_u32 s49, 2
    s_cmov_b32 s54, 1536
    s_cmp_eq_u32 s49, 3
    s_cmov_b32 s54, 1920
    s_cmp_eq_u32 s49, 1
    s_cmov_b32 s55, 32
    s_bfm_b64 s[14:15], s55, 0
    s_cmp_eq_u32 s49, 0
    s_cmov_b64 s[14:15], -1
    s_add_u32 s54, s54, 159744
    v_add_u32 v230, s54, v9
    s_waitcnt vmcnt(12)
    v_lshlrev_b32 v232, 16, v228
    v_and_b32 v233, 0xffff0000, v228
    v_lshlrev_b32 v234, 16, v229
    v_and_b32 v235, 0xffff0000, v229
    v_mul_f32 v232, s63, v232
    v_mul_f32 v233, s63, v233
    v_mul_f32 v234, s63, v234
    v_mul_f32 v235, s63, v235
    s_mov_b64 exec, s[14:15]
    ds_write_b128 v230, v[232:235]
    s_mov_b64 exec, -1
    s_waitcnt lgkmcnt(9)
    ds_read_b64_tr_b16 v[148:149], v222 offset:64
    ds_read_b64_tr_b16 v[150:151], v222 offset:1024
    ds_read_b64_tr_b16 v[152:153], v223 offset:64
    ds_read_b64_tr_b16 v[154:155], v223 offset:1024
    v_and_b32 v28, v124, v224
    v_and_b32 v29, v124, v226
    v_and_b32 v172, v124, v225
    v_and_b32 v173, v124, v227
    v_and_b32 v76, v125, v224
    v_and_b32 v77, v125, v226
    v_and_b32 v124, v125, v225
    v_and_b32 v125, v125, v227
    v_and_b32 v30, v126, v224
    v_and_b32 v31, v126, v226
    v_and_b32 v174, v126, v225
    v_and_b32 v175, v126, v227
    v_and_b32 v78, v127, v224
    v_and_b32 v79, v127, v226
    v_and_b32 v126, v127, v225
    v_and_b32 v127, v127, v227
    v_and_b32 v32, v128, v224
    v_and_b32 v33, v128, v226
    v_and_b32 v176, v128, v225
    v_and_b32 v177, v128, v227
    v_and_b32 v80, v129, v224
    v_and_b32 v81, v129, v226
    v_and_b32 v128, v129, v225
    v_and_b32 v129, v129, v227
    v_and_b32 v34, v130, v224
    v_and_b32 v35, v130, v226
    v_and_b32 v178, v130, v225
    v_and_b32 v179, v130, v227
    v_and_b32 v82, v131, v224
    v_and_b32 v83, v131, v226
    v_and_b32 v130, v131, v225
    v_and_b32 v131, v131, v227
    s_waitcnt lgkmcnt(9)
    ds_read_b64_tr_b16 v[156:157], v220 offset:128
    ds_read_b64_tr_b16 v[158:159], v220 offset:1088
    ds_read_b64_tr_b16 v[160:161], v221 offset:128
    ds_read_b64_tr_b16 v[162:163], v221 offset:1088
    v_and_b32 v36, v132, v224
    v_and_b32 v37, v132, v226
    v_and_b32 v180, v132, v225
    v_and_b32 v181, v132, v227
    v_and_b32 v84, v133, v224
    v_and_b32 v85, v133, v226
    v_and_b32 v132, v133, v225
    v_and_b32 v133, v133, v227
    v_and_b32 v38, v134, v224
    v_and_b32 v39, v134, v226
    v_and_b32 v182, v134, v225
    v_and_b32 v183, v134, v227
    v_and_b32 v86, v135, v224
    v_and_b32 v87, v135, v226
    v_and_b32 v134, v135, v225
    v_and_b32 v135, v135, v227
    v_and_b32 v40, v136, v224
    v_and_b32 v41, v136, v226
    v_and_b32 v184, v136, v225
    v_and_b32 v185, v136, v227
    v_and_b32 v88, v137, v224
    v_and_b32 v89, v137, v226
    v_and_b32 v136, v137, v225
    v_and_b32 v137, v137, v227
    v_and_b32 v42, v138, v224
    v_and_b32 v43, v138, v226
    v_and_b32 v186, v138, v225
    v_and_b32 v187, v138, v227
    v_and_b32 v90, v139, v224
    v_and_b32 v91, v139, v226
    v_and_b32 v138, v139, v225
    v_and_b32 v139, v139, v227
    s_waitcnt lgkmcnt(9)
    ds_read_b64_tr_b16 v[164:165], v222 offset:128
    ds_read_b64_tr_b16 v[166:167], v222 offset:1088
    ds_read_b64_tr_b16 v[168:169], v223 offset:128
    ds_read_b64_tr_b16 v[170:171], v223 offset:1088
    v_and_b32 v44, v140, v224
    v_and_b32 v45, v140, v226
    v_and_b32 v188, v140, v225
    v_and_b32 v189, v140, v227
    v_and_b32 v92, v141, v224
    v_and_b32 v93, v141, v226
    v_and_b32 v140, v141, v225
    v_and_b32 v141, v141, v227
    v_and_b32 v46, v142, v224
    v_and_b32 v47, v142, v226
    v_and_b32 v190, v142, v225
    v_and_b32 v191, v142, v227
    v_and_b32 v94, v143, v224
    v_and_b32 v95, v143, v226
    v_and_b32 v142, v143, v225
    v_and_b32 v143, v143, v227
    v_and_b32 v48, v144, v224
    v_and_b32 v49, v144, v226
    v_and_b32 v192, v144, v225
    v_and_b32 v193, v144, v227
    v_and_b32 v96, v145, v224
    v_and_b32 v97, v145, v226
    v_and_b32 v144, v145, v225
    v_and_b32 v145, v145, v227
    v_and_b32 v50, v146, v224
    v_and_b32 v51, v146, v226
    v_and_b32 v194, v146, v225
    v_and_b32 v195, v146, v227
    v_and_b32 v98, v147, v224
    v_and_b32 v99, v147, v226
    v_and_b32 v146, v147, v225
    v_and_b32 v147, v147, v227
    s_waitcnt lgkmcnt(8)
    v_and_b32 v52, v148, v224
    v_and_b32 v53, v148, v226
    v_and_b32 v196, v148, v225
    v_and_b32 v197, v148, v227
    v_and_b32 v100, v149, v224
    v_and_b32 v101, v149, v226
    v_and_b32 v148, v149, v225
    v_and_b32 v149, v149, v227
    v_and_b32 v54, v150, v224
    v_and_b32 v55, v150, v226
    v_and_b32 v198, v150, v225
    v_and_b32 v199, v150, v227
    v_and_b32 v102, v151, v224
    v_and_b32 v103, v151, v226
    v_and_b32 v150, v151, v225
    v_and_b32 v151, v151, v227
    v_and_b32 v56, v152, v224
    v_and_b32 v57, v152, v226
    v_and_b32 v200, v152, v225
    v_and_b32 v201, v152, v227
    v_and_b32 v104, v153, v224
    v_and_b32 v105, v153, v226
    v_and_b32 v152, v153, v225
    v_and_b32 v153, v153, v227
    v_and_b32 v58, v154, v224
    v_and_b32 v59, v154, v226
    v_and_b32 v202, v154, v225
    v_and_b32 v203, v154, v227
    v_and_b32 v106, v155, v224
    v_and_b32 v107, v155, v226
    v_and_b32 v154, v155, v225
    v_and_b32 v155, v155, v227
    s_waitcnt lgkmcnt(4)
    v_and_b32 v60, v156, v224
    v_and_b32 v61, v156, v226
    v_and_b32 v204, v156, v225
    v_and_b32 v205, v156, v227
    v_and_b32 v108, v157, v224
    v_and_b32 v109, v157, v226
    v_and_b32 v156, v157, v225
    v_and_b32 v157, v157, v227
    v_and_b32 v62, v158, v224
    v_and_b32 v63, v158, v226
    v_and_b32 v206, v158, v225
    v_and_b32 v207, v158, v227
    v_and_b32 v110, v159, v224
    v_and_b32 v111, v159, v226
    v_and_b32 v158, v159, v225
    v_and_b32 v159, v159, v227
    v_and_b32 v64, v160, v224
    v_and_b32 v65, v160, v226
    v_and_b32 v208, v160, v225
    v_and_b32 v209, v160, v227
    v_and_b32 v112, v161, v224
    v_and_b32 v113, v161, v226
    v_and_b32 v160, v161, v225
    v_and_b32 v161, v161, v227
    v_and_b32 v66, v162, v224
    v_and_b32 v67, v162, v226
    v_and_b32 v210, v162, v225
    v_and_b32 v211, v162, v227
    v_and_b32 v114, v163, v224
    v_and_b32 v115, v163, v226
    v_and_b32 v162, v163, v225
    v_and_b32 v163, v163, v227
    s_waitcnt lgkmcnt(0)
    v_and_b32 v68, v164, v224
    v_and_b32 v69, v164, v226
    v_and_b32 v212, v164, v225
    v_and_b32 v213, v164, v227
    v_and_b32 v116, v165, v224
    v_and_b32 v117, v165, v226
    v_and_b32 v164, v165, v225
    v_and_b32 v165, v165, v227
    v_and_b32 v70, v166, v224
    v_and_b32 v71, v166, v226
    v_and_b32 v214, v166, v225
    v_and_b32 v215, v166, v227
    v_and_b32 v118, v167, v224
    v_and_b32 v119, v167, v226
    v_and_b32 v166, v167, v225
    v_and_b32 v167, v167, v227
    v_and_b32 v72, v168, v224
    v_and_b32 v73, v168, v226
    v_and_b32 v216, v168, v225
    v_and_b32 v217, v168, v227
    v_and_b32 v120, v169, v224
    v_and_b32 v121, v169, v226
    v_and_b32 v168, v169, v225
    v_and_b32 v169, v169, v227
    v_and_b32 v74, v170, v224
    v_and_b32 v75, v170, v226
    v_and_b32 v218, v170, v225
    v_and_b32 v219, v170, v227
    v_and_b32 v122, v171, v224
    v_and_b32 v123, v171, v226
    v_and_b32 v170, v171, v225
    v_and_b32 v171, v171, v227
    s_add_u32 s61, s61, 73728
    s_add_u32 s60, s60, 384
    v_or_b32 v1, v226, v227
    s_mov_b32 s14, 0xffff
    s_mov_b32 s15, 0xffff0000
    s_waitcnt vmcnt(0) lgkmcnt(0)
    s_barrier
L_convE:
    ds_read_b128 v[220:223], v252 offset:0
    ds_read_b128 v[224:227], v252 offset:7680
    ds_read_b128 v[228:231], v252 offset:64
    ds_read_b128 v[232:235], v252 offset:7744
    ds_read_b128 v[236:239], v252 offset:128
    ds_read_b128 v[240:243], v252 offset:7808
    ds_read_b128 v[244:247], v252 offset:15360
    ds_read_b128 v[248:251], v253 offset:0
    s_waitcnt lgkmcnt(6)
    v_smfmac_f32_16x16x64_bf16 v[16:19], v[28:31], v[220:227], v3
    ds_read_b128 v[220:223], v252 offset:15424
    ds_read_b128 v[224:227], v253 offset:64
    s_waitcnt lgkmcnt(6)
    v_smfmac_f32_16x16x64_bf16 v[20:23], v[44:47], v[228:235], v3
    ds_read_b128 v[228:231], v252 offset:15488
    ds_read_b128 v[232:235], v253 offset:128
    s_waitcnt lgkmcnt(6)
    v_smfmac_f32_16x16x64_bf16 v[24:27], v[60:63], v[236:243], v3
    ds_read_b128 v[236:239], v253 offset:7680
    ds_read_b128 v[240:243], v253 offset:15360
    s_waitcnt lgkmcnt(6)
    v_smfmac_f32_16x16x64_bf16 v[16:19], v[32:35], v[244:251], v3
    ds_read_b128 v[244:247], v253 offset:7744
    ds_read_b128 v[248:251], v253 offset:15424
    s_waitcnt lgkmcnt(6)
    v_smfmac_f32_16x16x64_bf16 v[20:23], v[48:51], v[220:227], v3
    ds_read_b128 v[220:223], v253 offset:7808
    ds_read_b128 v[224:227], v253 offset:15488
    s_waitcnt lgkmcnt(6)
    v_smfmac_f32_16x16x64_bf16 v[24:27], v[64:67], v[228:235], v3
    ds_read_b128 v[228:231], v254 offset:0
    ds_read_b128 v[232:235], v255 offset:0
    s_waitcnt lgkmcnt(6)
    v_smfmac_f32_16x16x64_bf16 v[16:19], v[36:39], v[236:243], v3
    ds_read_b128 v[236:239], v254 offset:64
    ds_read_b128 v[240:243], v255 offset:64
    s_waitcnt lgkmcnt(6)
    v_smfmac_f32_16x16x64_bf16 v[20:23], v[52:55], v[244:251], v3
    ds_read_b128 v[244:247], v254 offset:128
    ds_read_b128 v[248:251], v255 offset:128
    s_waitcnt lgkmcnt(6)
    v_smfmac_f32_16x16x64_bf16 v[24:27], v[68:71], v[220:227], v3
    v_xor_b32 v252, 16, v252
    ds_read_b128 v[220:223], v252 offset:0
    ds_read_b128 v[224:227], v252 offset:7680
    s_waitcnt lgkmcnt(6)
    v_smfmac_f32_16x16x64_bf16 v[16:19], v[40:43], v[228:235], v3
    ds_read_b128 v[228:231], v252 offset:64
    ds_read_b128 v[232:235], v252 offset:7744
    v_mov_b32 v28, 0
    v_mov_b32 v29, 0
    v_mov_b32 v30, 0
    v_mov_b32 v31, 0
    s_waitcnt lgkmcnt(6)
    v_smfmac_f32_16x16x64_bf16 v[20:23], v[56:59], v[236:243], v3
    ds_read_b128 v[236:239], v252 offset:128
    ds_read_b128 v[240:243], v252 offset:7808
    v_mov_b32 v32, 0
    v_mov_b32 v33, 0
    v_mov_b32 v34, 0
    v_mov_b32 v35, 0
    s_waitcnt lgkmcnt(6)
    v_smfmac_f32_16x16x64_bf16 v[24:27], v[72:75], v[244:251], v3
    ds_read_b128 v[244:247], v252 offset:15360
    v_xor_b32 v253, 16, v253
    ds_read_b128 v[248:251], v253 offset:0
    ds_read_b128 v[64:67], v252 offset:15424
    ds_read_b128 v[68:71], v253 offset:64
    v_mov_b32 v36, 0
    v_mov_b32 v37, 0
    v_mov_b32 v38, 0
    v_mov_b32 v39, 0
    s_waitcnt lgkmcnt(6)
    v_smfmac_f32_16x16x64_bf16 v[28:31], v[172:175], v[220:227], v3
    ds_read_b128 v[220:223], v252 offset:15488
    ds_read_b128 v[224:227], v253 offset:128
    v_mov_b32 v40, 0
    v_smfmac_f32_16x16x64_bf16 v[32:35], v[188:191], v[228:235], v3
    ds_read_b128 v[228:231], v253 offset:7680
    ds_read_b128 v[232:235], v253 offset:15360
    v_mov_b32 v41, 0
    s_waitcnt lgkmcnt(6)
    v_smfmac_f32_16x16x64_bf16 v[36:39], v[204:207], v[236:243], v3
    ds_read_b128 v[236:239], v253 offset:7744
    ds_read_b128 v[240:243], v253 offset:15424
    v_mov_b32 v42, 0
    v_mov_b32 v43, 0
    v_smfmac_f32_16x16x64_bf16 v[28:31], v[176:179], v[244:251], v3
    ds_read_b128 v[244:247], v253 offset:7808
    ds_read_b128 v[248:251], v253 offset:15488
    v_mov_b32 v44, 0
    s_waitcnt lgkmcnt(6)
    v_smfmac_f32_16x16x64_bf16 v[32:35], v[192:195], v[64:71], v3
    v_xor_b32 v254, 16, v254
    ds_read_b128 v[64:67], v254 offset:0
    v_xor_b32 v255, 16, v255
    ds_read_b128 v[68:71], v255 offset:0
    v_mov_b32 v45, 0
    v_smfmac_f32_16x16x64_bf16 v[36:39], v[208:211], v[220:227], v3
    ds_read_b128 v[220:223], v254 offset:64
    ds_read_b128 v[224:227], v255 offset:64
    v_mov_b32 v46, 0
    v_mov_b32 v47, 0
    s_waitcnt lgkmcnt(6)
    v_smfmac_f32_16x16x64_bf16 v[28:31], v[180:183], v[228:235], v3
    ds_read_b128 v[228:231], v254 offset:128
    ds_read_b128 v[232:235], v255 offset:128
    v_mov_b32 v48, 0
    v_smfmac_f32_16x16x64_bf16 v[32:35], v[196:199], v[236:243], v3
    v_xor_b32 v252, 48, v252
    ds_read_b128 v[236:239], v252 offset:0
    ds_read_b128 v[240:243], v252 offset:7680
    v_mov_b32 v49, 0
    s_waitcnt lgkmcnt(6)
    v_smfmac_f32_16x16x64_bf16 v[36:39], v[212:215], v[244:251], v3
    ds_read_b128 v[244:247], v252 offset:64
    ds_read_b128 v[248:251], v252 offset:7744
    v_mov_b32 v50, 0
    v_mov_b32 v51, 0
    v_smfmac_f32_16x16x64_bf16 v[28:31], v[184:187], v[64:71], v3
    ds_read_b128 v[64:67], v252 offset:128
    ds_read_b128 v[68:71], v252 offset:7808
    s_waitcnt lgkmcnt(6)
    v_smfmac_f32_16x16x64_bf16 v[32:35], v[200:203], v[220:227], v3
    ds_read_b128 v[220:223], v252 offset:15360
    v_xor_b32 v253, 48, v253
    ds_read_b128 v[224:227], v253 offset:0
    v_smfmac_f32_16x16x64_bf16 v[36:39], v[216:219], v[228:235], v3
    ds_read_b128 v[228:231], v252 offset:15424
    ds_read_b128 v[232:235], v253 offset:64
    s_waitcnt lgkmcnt(6)
    v_smfmac_f32_16x16x64_bf16 v[40:43], v[76:79], v[236:243], v3
    ds_read_b128 v[172:175], v252 offset:15488
    ds_read_b128 v[176:179], v253 offset:128
    v_mov_b32 v52, 0
    v_smfmac_f32_16x16x64_bf16 v[44:47], v[92:95], v[244:251], v3
    ds_read_b128 v[180:183], v253 offset:7680
    ds_read_b128 v[184:187], v253 offset:15360
    v_mov_b32 v53, 0
    s_waitcnt lgkmcnt(6)
    v_smfmac_f32_16x16x64_bf16 v[48:51], v[108:111], v[64:71], v3
    ds_read_b128 v[236:239], v253 offset:7744
    ds_read_b128 v[240:243], v253 offset:15424
    v_mov_b32 v54, 0
    v_mov_b32 v55, 0
    v_smfmac_f32_16x16x64_bf16 v[40:43], v[80:83], v[220:227], v3
    ds_read_b128 v[244:247], v253 offset:7808
    ds_read_b128 v[248:251], v253 offset:15488
    v_mov_b32 v56, 0
    s_waitcnt lgkmcnt(6)
    v_smfmac_f32_16x16x64_bf16 v[44:47], v[96:99], v[228:235], v3
    v_xor_b32 v254, 48, v254
    ds_read_b128 v[64:67], v254 offset:0
    v_xor_b32 v255, 48, v255
    ds_read_b128 v[68:71], v255 offset:0
    v_mov_b32 v57, 0
    v_smfmac_f32_16x16x64_bf16 v[48:51], v[112:115], v[172:179], v3
    ds_read_b128 v[220:223], v254 offset:64
    ds_read_b128 v[224:227], v255 offset:64
    v_mov_b32 v58, 0
    v_mov_b32 v59, 0
    s_waitcnt lgkmcnt(6)
    v_smfmac_f32_16x16x64_bf16 v[40:43], v[84:87], v[180:187], v3
    ds_read_b128 v[228:231], v254 offset:128
    ds_read_b128 v[232:235], v255 offset:128
    v_mov_b32 v60, 0
    v_smfmac_f32_16x16x64_bf16 v[44:47], v[100:103], v[236:243], v3
    v_xor_b32 v252, 16, v252
    ds_read_b128 v[172:175], v252 offset:0
    ds_read_b128 v[176:179], v252 offset:7680
    v_mov_b32 v61, 0
    s_waitcnt lgkmcnt(6)
    v_smfmac_f32_16x16x64_bf16 v[48:51], v[116:119], v[244:251], v3
    ds_read_b128 v[180:183], v252 offset:64
    ds_read_b128 v[184:187], v252 offset:7744
    v_mov_b32 v62, 0
    v_mov_b32 v63, 0
    v_smfmac_f32_16x16x64_bf16 v[40:43], v[88:91], v[64:71], v3
    ds_read_b128 v[236:239], v252 offset:128
    ds_read_b128 v[240:243], v252 offset:7808
    s_waitcnt lgkmcnt(6)
    v_smfmac_f32_16x16x64_bf16 v[44:47], v[104:107], v[220:227], v3
    ds_read_b128 v[244:247], v252 offset:15360
    v_xor_b32 v253, 16, v253
    ds_read_b128 v[248:251], v253 offset:0
    v_smfmac_f32_16x16x64_bf16 v[48:51], v[120:123], v[228:235], v3
    ds_read_b128 v[64:67], v252 offset:15424
    ds_read_b128 v[68:71], v253 offset:64
    s_waitcnt lgkmcnt(6)
    v_smfmac_f32_16x16x64_bf16 v[52:55], v[124:127], v[172:179], v3
    ds_read_b128 v[76:79], v252 offset:15488
    ds_read_b128 v[80:83], v253 offset:128
    v_smfmac_f32_16x16x64_bf16 v[56:59], v[140:143], v[180:187], v3
    ds_read_b128 v[84:87], v253 offset:7680
    ds_read_b128 v[88:91], v253 offset:15360
    s_waitcnt lgkmcnt(6)
    v_smfmac_f32_16x16x64_bf16 v[60:63], v[156:159], v[236:243], v3
    ds_read_b128 v[172:175], v253 offset:7744
    ds_read_b128 v[176:179], v253 offset:15424
    v_smfmac_f32_16x16x64_bf16 v[52:55], v[128:131], v[244:251], v3
    ds_read_b128 v[180:183], v253 offset:7808
    ds_read_b128 v[184:187], v253 offset:15488
    s_waitcnt lgkmcnt(6)
    v_smfmac_f32_16x16x64_bf16 v[56:59], v[144:147], v[64:71], v3
    v_xor_b32 v254, 16, v254
    ds_read_b128 v[236:239], v254 offset:0
    v_xor_b32 v255, 16, v255
    ds_read_b128 v[240:243], v255 offset:0
    v_smfmac_f32_16x16x64_bf16 v[60:63], v[160:163], v[76:83], v3
    ds_read_b128 v[244:247], v254 offset:64
    ds_read_b128 v[248:251], v255 offset:64
    s_waitcnt lgkmcnt(6)
    v_smfmac_f32_16x16x64_bf16 v[52:55], v[132:135], v[84:91], v3
    ds_read_b128 v[64:67], v254 offset:128
    ds_read_b128 v[68:71], v255 offset:128
    v_smfmac_f32_16x16x64_bf16 v[56:59], v[148:151], v[172:179], v3
    s_waitcnt lgkmcnt(6)
    v_smfmac_f32_16x16x64_bf16 v[60:63], v[164:167], v[180:187], v3
    ds_read_b128 v[208:211], v7 offset:0
    ds_read_b128 v[216:219], v7 offset:64
    ds_read_b128 v[224:227], v7 offset:128
    v_xor_b32 v7, 32, v7
    ds_read_b128 v[212:215], v7 offset:0
    ds_read_b128 v[220:223], v7 offset:64
    ds_read_b128 v[228:231], v7 offset:128
    s_waitcnt lgkmcnt(10)
    v_smfmac_f32_16x16x64_bf16 v[52:55], v[136:139], v[236:243], v3
    s_waitcnt lgkmcnt(8)
    v_smfmac_f32_16x16x64_bf16 v[56:59], v[152:155], v[244:251], v3
    s_waitcnt lgkmcnt(6)
    v_smfmac_f32_16x16x64_bf16 v[60:63], v[168:171], v[64:71], v3
    s_waitcnt lgkmcnt(0)
    s_barrier
    ds_read_b128 v[192:195], v6 offset:0
    ds_read_b128 v[196:199], v6 offset:32
    ds_read_b128 v[200:203], v6 offset:64
    ds_read_b128 v[204:207], v6 offset:96
    ds_read_b64_tr_b16 v[120:121], v4 offset:0
    ds_read_b64_tr_b16 v[122:123], v4 offset:1024
    ds_read_b64_tr_b16 v[124:125], v4 offset:2048
    ds_read_b64_tr_b16 v[126:127], v4 offset:3072
    ds_read_b64_tr_b16 v[128:129], v4 offset:4096
    ds_read_b64_tr_b16 v[130:131], v4 offset:5120
    ds_read_b64_tr_b16 v[132:133], v4 offset:6144
    ds_read_b64_tr_b16 v[134:135], v4 offset:7168
    ds_read_b64_tr_b16 v[136:137], v4 offset:8192
    ds_read_b64_tr_b16 v[138:139], v4 offset:9216
    ds_read_b64_tr_b16 v[140:141], v4 offset:10240
    ds_read_b64_tr_b16 v[142:143], v4 offset:11264
    v_pk_add_f32 v[72:73], v[16:17], v[18:19]
    v_pk_mul_f32 v[74:75], v[16:17], v[16:17]
    v_pk_add_f32 v[234:235], v[20:21], v[22:23]
    v_pk_mul_f32 v[236:237], v[18:19], v[18:19]
    v_pk_fma_f32 v[74:75], v[20:21], v[20:21], v[74:75]
    v_pk_fma_f32 v[236:237], v[22:23], v[22:23], v[236:237]
    v_pk_add_f32 v[72:73], v[72:73], v[24:25]
    v_pk_fma_f32 v[74:75], v[24:25], v[24:25], v[74:75]
    v_pk_add_f32 v[234:235], v[234:235], v[26:27]
    v_pk_fma_f32 v[236:237], v[26:27], v[26:27], v[236:237]
    v_pk_add_f32 v[72:73], v[72:73], v[28:29]
    v_pk_fma_f32 v[74:75], v[28:29], v[28:29], v[74:75]
    v_pk_add_f32 v[234:235], v[234:235], v[30:31]
    v_pk_fma_f32 v[236:237], v[30:31], v[30:31], v[236:237]
    v_pk_add_f32 v[72:73], v[72:73], v[32:33]
    v_pk_fma_f32 v[74:75], v[32:33], v[32:33], v[74:75]
    v_pk_add_f32 v[234:235], v[234:235], v[34:35]
    v_pk_fma_f32 v[236:237], v[34:35], v[34:35], v[236:237]
    v_pk_add_f32 v[72:73], v[72:73], v[36:37]
    v_pk_fma_f32 v[74:75], v[36:37], v[36:37], v[74:75]
    v_pk_add_f32 v[234:235], v[234:235], v[38:39]
    v_pk_fma_f32 v[236:237], v[38:39], v[38:39], v[236:237]
    v_pk_add_f32 v[72:73], v[72:73], v[40:41]
    v_pk_fma_f32 v[74:75], v[40:41], v[40:41], v[74:75]
    v_pk_add_f32 v[234:235], v[234:235], v[42:43]
    v_pk_fma_f32 v[236:237], v[42:43], v[42:43], v[236:237]
    v_pk_add_f32 v[72:73], v[72:73], v[44:45]
    v_pk_fma_f32 v[74:75], v[44:45], v[44:45], v[74:75]
    v_pk_add_f32 v[234:235], v[234:235], v[46:47]
    v_pk_fma_f32 v[236:237], v[46:47], v[46:47], v[236:237]
    v_pk_add_f32 v[72:73], v[72:73], v[48:49]
    v_pk_fma_f32 v[74:75], v[48:49], v[48:49], v[74:75]
    v_pk_add_f32 v[234:235], v[234:235], v[50:51]
    v_pk_fma_f32 v[236:237], v[50:51], v[50:51], v[236:237]
    v_pk_add_f32 v[72:73], v[72:73], v[52:53]
    v_pk_fma_f32 v[74:75], v[52:53], v[52:53], v[74:75]
    v_pk_add_f32 v[234:235], v[234:235], v[54:55]
    v_pk_fma_f32 v[236:237], v[54:55], v[54:55], v[236:237]
    v_pk_add_f32 v[72:73], v[72:73], v[56:57]
    v_pk_fma_f32 v[74:75], v[56:57], v[56:57], v[74:75]
    v_pk_add_f32 v[234:235], v[234:235], v[58:59]
    v_pk_fma_f32 v[236:237], v[58:59], v[58:59], v[236:237]
    v_pk_add_f32 v[72:73], v[72:73], v[60:61]
    v_pk_fma_f32 v[74:75], v[60:61], v[60:61], v[74:75]
    v_pk_add_f32 v[234:235], v[234:235], v[62:63]
    v_pk_fma_f32 v[236:237], v[62:63], v[62:63], v[236:237]
    v_pk_add_f32 v[72:73], v[72:73], v[234:235]
    v_pk_add_f32 v[74:75], v[74:75], v[236:237]
    s_setprio 2
    v_add_f32 v72, v72, v73
    v_add_f32 v74, v74, v75
    v_mov_b32 v73, v72
    v_mov_b32 v75, v74
    s_nop 0
    v_permlane32_swap_b32 v72, v73
    v_permlane32_swap_b32 v74, v75
    v_add_f32 v72, v72, v73
    v_add_f32 v74, v74, v75
    v_mul_f32 v72, 0x3c2aaaab, v72
    v_mul_f32 v74, 0x3c2aaaab, v74
    v_fma_f32 v74, -v72, v72, v74
    v_max_f32 v74, 0, v74
    v_add_f32 v74, 0x3727c5ac, v74
    v_rsq_f32 v233, v74
    s_nop 0
    v_mul_f32 v232, 0xbeeff558, v233
    v_mul_f32 v233, 0xbeeff558, v233
    v_mul_f32_e64 v234, -v72, v232
    v_mul_f32_e64 v235, -v72, v232
    v_fma_f32 v16, v16, v232, v234
    v_fma_f32 v17, v17, v232, v234
    v_fma_f32 v18, v18, v232, v234
    v_fma_f32 v19, v19, v232, v234
    v_fma_f32 v28, v28, v232, v234
    v_fma_f32 v29, v29, v232, v234
    v_fma_f32 v30, v30, v232, v234
    v_fma_f32 v31, v31, v232, v234
    v_cvt_pk_bf16_f32 v96, v16, v17
    v_cvt_pk_bf16_f32 v97, v18, v19
    v_cvt_pk_bf16_f32 v98, v28, v29
    v_cvt_pk_bf16_f32 v99, v30, v31
    v_fma_f32 v40, v40, v232, v234
    v_fma_f32 v41, v41, v232, v234
    v_fma_f32 v42, v42, v232, v234
    v_fma_f32 v43, v43, v232, v234
    v_fma_f32 v52, v52, v232, v234
    v_fma_f32 v53, v53, v232, v234
    v_fma_f32 v54, v54, v232, v234
    v_fma_f32 v55, v55, v232, v234
    s_waitcnt lgkmcnt(0)
    v_mfma_f32_32x32x16_bf16 v[64:79], v[120:123], v[96:99], v[192:207]
    v_cvt_pk_bf16_f32 v100, v40, v41
    v_cvt_pk_bf16_f32 v101, v42, v43
    v_cvt_pk_bf16_f32 v102, v52, v53
    v_cvt_pk_bf16_f32 v103, v54, v55
    v_fma_f32 v20, v20, v232, v234
    v_fma_f32 v21, v21, v232, v234
    v_fma_f32 v22, v22, v232, v234
    v_fma_f32 v23, v23, v232, v234
    v_fma_f32 v32, v32, v232, v234
    v_fma_f32 v33, v33, v232, v234
    v_fma_f32 v34, v34, v232, v234
    v_fma_f32 v35, v35, v232, v234
    v_mfma_f32_32x32x16_bf16 v[64:79], v[124:127], v[100:103], v[64:79]
    v_cvt_pk_bf16_f32 v104, v20, v21
    v_cvt_pk_bf16_f32 v105, v22, v23
    v_cvt_pk_bf16_f32 v106, v32, v33
    v_cvt_pk_bf16_f32 v107, v34, v35
    v_fma_f32 v44, v44, v232, v234
    v_fma_f32 v45, v45, v232, v234
    v_fma_f32 v46, v46, v232, v234
    v_fma_f32 v47, v47, v232, v234
    v_fma_f32 v56, v56, v232, v234
    v_fma_f32 v57, v57, v232, v234
    v_fma_f32 v58, v58, v232, v234
    v_fma_f32 v59, v59, v232, v234
    v_mfma_f32_32x32x16_bf16 v[64:79], v[128:131], v[104:107], v[64:79]
    v_cvt_pk_bf16_f32 v108, v44, v45
    v_cvt_pk_bf16_f32 v109, v46, v47
    v_cvt_pk_bf16_f32 v110, v56, v57
    v_cvt_pk_bf16_f32 v111, v58, v59
    v_fma_f32 v24, v24, v232, v234
    v_fma_f32 v25, v25, v232, v234
    v_fma_f32 v26, v26, v232, v234
    v_fma_f32 v27, v27, v232, v234
    v_fma_f32 v36, v36, v232, v234
    v_fma_f32 v37, v37, v232, v234
    v_fma_f32 v38, v38, v232, v234
    v_fma_f32 v39, v39, v232, v234
    v_mfma_f32_32x32x16_bf16 v[64:79], v[132:135], v[108:111], v[64:79]
    v_cvt_pk_bf16_f32 v112, v24, v25
    v_cvt_pk_bf16_f32 v113, v26, v27
    v_cvt_pk_bf16_f32 v114, v36, v37
    v_cvt_pk_bf16_f32 v115, v38, v39
    v_fma_f32 v48, v48, v232, v234
    v_fma_f32 v49, v49, v232, v234
    v_fma_f32 v50, v50, v232, v234
    v_fma_f32 v51, v51, v232, v234
    v_fma_f32 v60, v60, v232, v234
    v_fma_f32 v61, v61, v232, v234
    v_fma_f32 v62, v62, v232, v234
    v_fma_f32 v63, v63, v232, v234
    v_mfma_f32_32x32x16_bf16 v[64:79], v[136:139], v[112:115], v[64:79]
    v_cvt_pk_bf16_f32 v116, v48, v49
    v_cvt_pk_bf16_f32 v117, v50, v51
    v_cvt_pk_bf16_f32 v118, v60, v61
    v_cvt_pk_bf16_f32 v119, v62, v63
    ds_read_b128 v[16:19], v13 offset:1536
    ds_read_b128 v[20:23], v13 offset:1552
    v_mfma_f32_32x32x16_bf16 v[64:79], v[140:143], v[116:119], v[64:79]
    ds_read_b128 v[24:27], v13 offset:1600
    ds_read_b128 v[28:31], v13 offset:1616
    ds_read_b128 v[32:35], v13 offset:1664
    ds_read_b128 v[36:39], v13 offset:1680
    ds_read_b128 v[40:43], v13 offset:1728
    ds_read_b128 v[44:47], v13 offset:1744
    ds_read_b128 v[48:51], v13 offset:1792
    ds_read_b128 v[52:55], v13 offset:1808
    ds_read_b128 v[56:59], v13 offset:1856
    ds_read_b128 v[60:63], v13 offset:1872
    s_setprio 3
    v_mov_b32 v3, 7
    s_mov_b32 s4, 1.0
    s_mov_b32 s5, 1.0
    s_mov_b32 s6, 0x409d30fc
    s_mov_b32 s7, 0x409d30fc
    v_pk_fma_f32 v[176:177], v[64:65], v[64:65], s[6:7]
    v_pk_fma_f32 v[178:179], v[66:67], v[66:67], s[6:7]
    v_pk_fma_f32 v[180:181], v[68:69], v[68:69], s[6:7]
    v_pk_fma_f32 v[182:183], v[70:71], v[70:71], s[6:7]
    v_pk_mul_f32 v[176:177], v[64:65], v[176:177]
    v_pk_mul_f32 v[178:179], v[66:67], v[178:179]
    v_pk_mul_f32 v[180:181], v[68:69], v[180:181]
    v_pk_mul_f32 v[182:183], v[70:71], v[182:183]
    s_waitcnt lgkmcnt(0)
    ds_read_b128 v[192:195], v6 offset:128
    ds_read_b128 v[196:199], v6 offset:160
    ds_read_b128 v[200:203], v6 offset:192
    ds_read_b128 v[204:207], v6 offset:224
    ds_read_b64_tr_b16 v[120:121], v4 offset:512
    ds_read_b64_tr_b16 v[122:123], v4 offset:1536
    ds_read_b64_tr_b16 v[124:125], v4 offset:2560
    ds_read_b64_tr_b16 v[126:127], v4 offset:3584
    ds_read_b64_tr_b16 v[128:129], v4 offset:4608
    ds_read_b64_tr_b16 v[130:131], v4 offset:5632
    ds_read_b64_tr_b16 v[132:133], v4 offset:6656
    ds_read_b64_tr_b16 v[134:135], v4 offset:7680
    ds_read_b64_tr_b16 v[136:137], v4 offset:8704
    ds_read_b64_tr_b16 v[138:139], v4 offset:9728
    ds_read_b64_tr_b16 v[140:141], v4 offset:10752
    ds_read_b64_tr_b16 v[142:143], v4 offset:11776
    s_add_u32 m0, s61, 0
    s_add_u32 s54, s60, 0
    buffer_load_dwordx4 v2, s[32:35], s54 offen lds
    ds_read_b32 v0, v15 offset:4
    s_setprio 1
    v_exp_f32 v176, v176
    v_exp_f32 v177, v177
    v_exp_f32 v178, v178
    v_exp_f32 v179, v179
    v_exp_f32 v180, v180
    v_exp_f32 v181, v181
    v_exp_f32 v182, v182
    v_exp_f32 v183, v183
    s_setprio 3
    v_pk_add_f32 v[176:177], v[176:177], s[4:5]
    v_pk_add_f32 v[178:179], v[178:179], s[4:5]
    v_pk_add_f32 v[180:181], v[180:181], s[4:5]
    v_pk_add_f32 v[182:183], v[182:183], s[4:5]
    v_pk_fma_f32 v[184:185], v[72:73], v[72:73], s[6:7]
    v_pk_fma_f32 v[186:187], v[74:75], v[74:75], s[6:7]
    v_pk_fma_f32 v[188:189], v[76:77], v[76:77], s[6:7]
    v_pk_fma_f32 v[190:191], v[78:79], v[78:79], s[6:7]
    v_pk_mul_f32 v[184:185], v[72:73], v[184:185]
    v_pk_mul_f32 v[186:187], v[74:75], v[186:187]
    v_pk_mul_f32 v[188:189], v[76:77], v[188:189]
    v_pk_mul_f32 v[190:191], v[78:79], v[190:191]
    s_waitcnt lgkmcnt(0)
    v_readfirstlane_b32 s54, v0
    s_nop 0
    s_add_u32 s54, s54, 0x7b7b7b7b
    s_andn2_b32 s54, 0x80808080, s54
    s_cbranch_scc0 L_needE1_ok
L_needE1:
    ds_read_b32 v0, v15 offset:4
    s_waitcnt lgkmcnt(0)
    v_readfirstlane_b32 s54, v0
    s_nop 0
    s_add_u32 s54, s54, 0x7b7b7b7b
    s_andn2_b32 s54, 0x80808080, s54
    s_cbranch_scc1 L_needE1
L_needE1_ok:
    ds_read_b64_tr_b16 v[156:157], v5 offset:12288
    ds_read_b64_tr_b16 v[158:159], v5 offset:13824
    ds_read_b64_tr_b16 v[160:161], v5 offset:12352
    ds_read_b64_tr_b16 v[162:163], v5 offset:13888
    ds_read_b64_tr_b16 v[164:165], v5 offset:12416
    ds_read_b64_tr_b16 v[166:167], v5 offset:13952
    s_add_u32 m0, s61, 1024
    s_add_u32 s54, s60, 6144
    buffer_load_dwordx4 v2, s[32:35], s54 offen lds
    s_setprio 1
    v_mfma_f32_32x32x16_bf16 v[80:95], v[120:123], v[96:99], v[192:207]
    v_rcp_f32 v176, v176
    v_rcp_f32 v177, v177
    v_rcp_f32 v178, v178
    v_mfma_f32_32x32x16_bf16 v[80:95], v[124:127], v[100:103], v[80:95]
    v_rcp_f32 v179, v179
    v_rcp_f32 v180, v180
    v_rcp_f32 v181, v181
    v_mfma_f32_32x32x16_bf16 v[80:95], v[128:131], v[104:107], v[80:95]
    v_rcp_f32 v182, v182
    v_rcp_f32 v183, v183
    v_exp_f32 v184, v184
    v_mfma_f32_32x32x16_bf16 v[80:95], v[132:135], v[108:111], v[80:95]
    v_exp_f32 v185, v185
    v_exp_f32 v186, v186
    v_exp_f32 v187, v187
    v_mfma_f32_32x32x16_bf16 v[80:95], v[136:139], v[112:115], v[80:95]
    v_exp_f32 v188, v188
    v_exp_f32 v189, v189
    v_exp_f32 v190, v190
    v_mfma_f32_32x32x16_bf16 v[80:95], v[140:143], v[116:119], v[80:95]
    v_exp_f32 v191, v191
    s_setprio 3
    v_pk_add_f32 v[184:185], v[184:185], s[4:5]
    v_pk_add_f32 v[186:187], v[186:187], s[4:5]
    v_pk_add_f32 v[188:189], v[188:189], s[4:5]
    v_pk_add_f32 v[190:191], v[190:191], s[4:5]
    v_pk_mul_f32 v[64:65], v[64:65], v[176:177]
    v_pk_mul_f32 v[66:67], v[66:67], v[178:179]
    v_pk_mul_f32 v[68:69], v[68:69], v[180:181]
    v_pk_mul_f32 v[70:71], v[70:71], v[182:183]
    s_nop 1
    v_pk_fma_f32 v[176:177], v[80:81], v[80:81], s[6:7]
    v_pk_fma_f32 v[178:179], v[82:83], v[82:83], s[6:7]
    v_pk_fma_f32 v[180:181], v[84:85], v[84:85], s[6:7]
    v_pk_fma_f32 v[182:183], v[86:87], v[86:87], s[6:7]
    v_pk_mul_f32 v[176:177], v[80:81], v[176:177]
    v_pk_mul_f32 v[178:179], v[82:83], v[178:179]
    v_pk_mul_f32 v[180:181], v[84:85], v[180:181]
    v_pk_mul_f32 v[182:183], v[86:87], v[182:183]
    s_waitcnt lgkmcnt(0)
    ds_read_b128 v[192:195], v6 offset:256
    ds_read_b128 v[196:199], v6 offset:288
    ds_read_b128 v[200:203], v6 offset:320
    ds_read_b128 v[204:207], v6 offset:352
    ds_read_b64_tr_b16 v[120:121], v4 offset:24576
    ds_read_b64_tr_b16 v[122:123], v4 offset:25600
    ds_read_b64_tr_b16 v[124:125], v4 offset:26624
    ds_read_b64_tr_b16 v[126:127], v4 offset:27648
    ds_read_b64_tr_b16 v[128:129], v4 offset:28672
    ds_read_b64_tr_b16 v[130:131], v4 offset:29696
    ds_read_b64_tr_b16 v[132:133], v4 offset:30720
    ds_read_b64_tr_b16 v[134:135], v4 offset:31744
    ds_read_b64_tr_b16 v[136:137], v4 offset:32768
    ds_read_b64_tr_b16 v[138:139], v4 offset:33792
    ds_read_b64_tr_b16 v[140:141], v4 offset:34816
    ds_read_b64_tr_b16 v[142:143], v4 offset:35840
    s_add_u32 m0, s61, 2048
    s_add_u32 s54, s60, 12288
    buffer_load_dwordx4 v2, s[32:35], s54 offen lds
    s_add_u32 s61, s61, 24576
    s_add_u32 s60, s60, 128
    s_setprio 1
    v_cvt_pk_bf16_f32 v168, v64, v65
    v_cvt_pk_bf16_f32 v169, v66, v67
    v_cvt_pk_bf16_f32 v170, v68, v69
    v_cvt_pk_bf16_f32 v171, v70, v71
    v_rcp_f32 v184, v184
    v_rcp_f32 v185, v185
    v_mfma_f32_32x32x16_bf16 v[16:31], v[156:159], v[168:171], v[16:31]
    v_rcp_f32 v186, v186
    v_rcp_f32 v187, v187
    v_rcp_f32 v188, v188
    v_mfma_f32_32x32x16_bf16 v[32:47], v[160:163], v[168:171], v[32:47]
    v_rcp_f32 v189, v189
    v_rcp_f32 v190, v190
    v_rcp_f32 v191, v191
    v_mfma_f32_32x32x16_bf16 v[48:63], v[164:167], v[168:171], v[48:63]
    v_exp_f32 v176, v176
    v_exp_f32 v177, v177
    v_exp_f32 v178, v178
    v_exp_f32 v179, v179
    v_exp_f32 v180, v180
    v_exp_f32 v181, v181
    v_exp_f32 v182, v182
    v_exp_f32 v183, v183
    s_setprio 3
    v_add_f32 v176, 1.0, v176
    v_add_f32 v177, 1.0, v177
    v_add_f32 v178, 1.0, v178
    v_add_f32 v179, 1.0, v179
    v_add_f32 v180, 1.0, v180
    v_add_f32 v181, 1.0, v181
    v_add_f32 v182, 1.0, v182
    v_add_f32 v183, 1.0, v183
    v_mul_f32 v248, v72, v184
    v_mul_f32 v249, v73, v185
    v_mul_f32 v250, v74, v186
    v_mul_f32 v251, v75, v187
    v_mul_f32 v252, v76, v188
    v_mul_f32 v253, v77, v189
    v_mul_f32 v254, v78, v190
    v_mul_f32 v255, v79, v191
    v_fmaak_f32 v184, v88, v88, 0x409d30fc
    v_fmaak_f32 v185, v89, v89, 0x409d30fc
    v_fmaak_f32 v186, v90, v90, 0x409d30fc
    v_fmaak_f32 v187, v91, v91, 0x409d30fc
    v_fmaak_f32 v188, v92, v92, 0x409d30fc
    v_fmaak_f32 v189, v93, v93, 0x409d30fc
    v_fmaak_f32 v190, v94, v94, 0x409d30fc
    v_fmaak_f32 v191, v95, v95, 0x409d30fc
    v_mul_f32 v184, v88, v184
    v_mul_f32 v185, v89, v185
    v_mul_f32 v186, v90, v186
    v_mul_f32 v187, v91, v187
    v_mul_f32 v188, v92, v188
    v_mul_f32 v189, v93, v189
    v_mul_f32 v190, v94, v190
    v_mul_f32 v191, v95, v191
    s_waitcnt lgkmcnt(0)
    ds_read_b64_tr_b16 v[144:145], v5 offset:15360
    ds_read_b64_tr_b16 v[146:147], v5 offset:16896
    ds_read_b64_tr_b16 v[148:149], v5 offset:15424
    ds_read_b64_tr_b16 v[150:151], v5 offset:16960
    ds_read_b64_tr_b16 v[152:153], v5 offset:15488
    ds_read_b64_tr_b16 v[154:155], v5 offset:17024
    ds_read_b64_tr_b16 v[156:157], v5 offset:18432
    ds_read_b64_tr_b16 v[158:159], v5 offset:19968
    ds_read_b64_tr_b16 v[160:161], v5 offset:18496
    ds_read_b64_tr_b16 v[162:163], v5 offset:20032
    ds_read_b64_tr_b16 v[164:165], v5 offset:18560
    ds_read_b64_tr_b16 v[166:167], v5 offset:20096
    ds_read_b32 v0, v15 offset:4
    s_setprio 1
    v_mfma_f32_32x32x16_bf16 v[64:79], v[120:123], v[96:99], v[192:207]
    v_cvt_pk_bf16_f32 v172, v248, v249
    v_cvt_pk_bf16_f32 v173, v250, v251
    v_rcp_f32 v176, v176
    v_rcp_f32 v177, v177
    v_mfma_f32_32x32x16_bf16 v[64:79], v[124:127], v[100:103], v[64:79]
    v_cvt_pk_bf16_f32 v174, v252, v253
    v_cvt_pk_bf16_f32 v175, v254, v255
    v_rcp_f32 v178, v178
    v_rcp_f32 v179, v179
    v_mfma_f32_32x32x16_bf16 v[64:79], v[128:131], v[104:107], v[64:79]
    v_rcp_f32 v180, v180
    v_rcp_f32 v181, v181
    v_rcp_f32 v182, v182
    v_mfma_f32_32x32x16_bf16 v[64:79], v[132:135], v[108:111], v[64:79]
    v_rcp_f32 v183, v183
    v_exp_f32 v184, v184
    v_exp_f32 v185, v185
    v_mfma_f32_32x32x16_bf16 v[64:79], v[136:139], v[112:115], v[64:79]
    v_exp_f32 v186, v186
    v_exp_f32 v187, v187
    v_exp_f32 v188, v188
    v_mfma_f32_32x32x16_bf16 v[64:79], v[140:143], v[116:119], v[64:79]
    v_exp_f32 v189, v189
    v_exp_f32 v190, v190
    v_exp_f32 v191, v191
    s_setprio 3
    v_add_f32 v184, 1.0, v184
    v_add_f32 v185, 1.0, v185
    v_add_f32 v186, 1.0, v186
    v_add_f32 v187, 1.0, v187
    v_add_f32 v188, 1.0, v188
    v_add_f32 v189, 1.0, v189
    v_add_f32 v190, 1.0, v190
    v_add_f32 v191, 1.0, v191
    v_mul_f32 v80, v80, v176
    v_mul_f32 v81, v81, v177
    v_mul_f32 v82, v82, v178
    v_mul_f32 v83, v83, v179
    v_mul_f32 v84, v84, v180
    v_mul_f32 v85, v85, v181
    v_mul_f32 v86, v86, v182
    v_mul_f32 v87, v87, v183
    v_fmaak_f32 v176, v64, v64, 0x409d30fc
    v_fmaak_f32 v177, v65, v65, 0x409d30fc
    v_fmaak_f32 v178, v66, v66, 0x409d30fc
    v_fmaak_f32 v179, v67, v67, 0x409d30fc
    v_fmaak_f32 v180, v68, v68, 0x409d30fc
    v_fmaak_f32 v181, v69, v69, 0x409d30fc
    v_fmaak_f32 v182, v70, v70, 0x409d30fc
    v_fmaak_f32 v183, v71, v71, 0x409d30fc
    v_mul_f32 v176, v64, v176
    v_mul_f32 v177, v65, v177
    v_mul_f32 v178, v66, v178
    v_mul_f32 v179, v67, v179
    v_mul_f32 v180, v68, v180
    v_mul_f32 v181, v69, v181
    v_mul_f32 v182, v70, v182
    v_mul_f32 v183, v71, v183
    s_waitcnt lgkmcnt(0)
    v_readfirstlane_b32 s54, v0
    s_nop 0
    s_add_u32 s54, s54, 0x7a7a7a7a
    s_andn2_b32 s54, 0x80808080, s54
    s_cbranch_scc0 L_needE4_ok
L_needE4:
    ds_read_b32 v0, v15 offset:4
    s_waitcnt lgkmcnt(0)
    v_readfirstlane_b32 s54, v0
    s_nop 0
    s_add_u32 s54, s54, 0x7a7a7a7a
    s_andn2_b32 s54, 0x80808080, s54
    s_cbranch_scc1 L_needE4
L_needE4_ok:
    ds_read_b128 v[192:195], v6 offset:384
    ds_read_b128 v[196:199], v6 offset:416
    ds_read_b128 v[200:203], v6 offset:448
    ds_read_b128 v[204:207], v6 offset:480
    ds_read_b64_tr_b16 v[120:121], v4 offset:25088
    ds_read_b64_tr_b16 v[122:123], v4 offset:26112
    ds_read_b64_tr_b16 v[124:125], v4 offset:27136
    ds_read_b64_tr_b16 v[126:127], v4 offset:28160
    ds_read_b64_tr_b16 v[128:129], v4 offset:29184
    ds_read_b64_tr_b16 v[130:131], v4 offset:30208
    ds_read_b64_tr_b16 v[132:133], v4 offset:31232
    ds_read_b64_tr_b16 v[134:135], v4 offset:32256
    ds_read_b64_tr_b16 v[136:137], v4 offset:33280
    ds_read_b64_tr_b16 v[138:139], v4 offset:34304
    ds_read_b64_tr_b16 v[140:141], v4 offset:35328
    ds_read_b64_tr_b16 v[142:143], v4 offset:36352
    s_waitcnt vmcnt(0)
    ds_write_b8 v14, v3
    s_add_u32 m0, s61, 0
    s_add_u32 s54, s60, 0
    buffer_load_dwordx4 v2, s[32:35], s54 offen lds
    s_setprio 1
    v_mfma_f32_32x32x16_bf16 v[16:31], v[144:147], v[172:175], v[16:31]
    v_cvt_pk_bf16_f32 v168, v80, v81
    v_cvt_pk_bf16_f32 v169, v82, v83
    v_rcp_f32 v184, v184
    v_rcp_f32 v185, v185
    v_mfma_f32_32x32x16_bf16 v[32:47], v[148:151], v[172:175], v[32:47]
    v_cvt_pk_bf16_f32 v170, v84, v85
    v_cvt_pk_bf16_f32 v171, v86, v87
    v_rcp_f32 v186, v186
    v_rcp_f32 v187, v187
    v_mfma_f32_32x32x16_bf16 v[48:63], v[152:155], v[172:175], v[48:63]
    v_rcp_f32 v188, v188
    v_rcp_f32 v189, v189
    v_rcp_f32 v190, v190
    v_mfma_f32_32x32x16_bf16 v[16:31], v[156:159], v[168:171], v[16:31]
    v_rcp_f32 v191, v191
    v_exp_f32 v176, v176
    v_exp_f32 v177, v177
    v_mfma_f32_32x32x16_bf16 v[32:47], v[160:163], v[168:171], v[32:47]
    v_exp_f32 v178, v178
    v_exp_f32 v179, v179
    v_exp_f32 v180, v180
    v_mfma_f32_32x32x16_bf16 v[48:63], v[164:167], v[168:171], v[48:63]
    v_exp_f32 v181, v181
    v_exp_f32 v182, v182
    v_exp_f32 v183, v183
    s_setprio 3
    v_add_f32 v176, 1.0, v176
    v_add_f32 v177, 1.0, v177
    v_add_f32 v178, 1.0, v178
    v_add_f32 v179, 1.0, v179
    v_add_f32 v180, 1.0, v180
    v_add_f32 v181, 1.0, v181
    v_add_f32 v182, 1.0, v182
    v_add_f32 v183, 1.0, v183
    v_mul_f32 v248, v88, v184
    v_mul_f32 v249, v89, v185
    v_mul_f32 v250, v90, v186
    v_mul_f32 v251, v91, v187
    v_mul_f32 v252, v92, v188
    v_mul_f32 v253, v93, v189
    v_mul_f32 v254, v94, v190
    v_mul_f32 v255, v95, v191
    v_fmaak_f32 v184, v72, v72, 0x409d30fc
    v_fmaak_f32 v185, v73, v73, 0x409d30fc
    v_fmaak_f32 v186, v74, v74, 0x409d30fc
    v_fmaak_f32 v187, v75, v75, 0x409d30fc
    v_fmaak_f32 v188, v76, v76, 0x409d30fc
    v_fmaak_f32 v189, v77, v77, 0x409d30fc
    v_fmaak_f32 v190, v78, v78, 0x409d30fc
    v_fmaak_f32 v191, v79, v79, 0x409d30fc
    v_mul_f32 v184, v72, v184
    v_mul_f32 v185, v73, v185
    v_mul_f32 v186, v74, v186
    v_mul_f32 v187, v75, v187
    v_mul_f32 v188, v76, v188
    v_mul_f32 v189, v77, v189
    v_mul_f32 v190, v78, v190
    v_mul_f32 v191, v79, v191
    v_add_u32 v3, 1, v3
    s_waitcnt lgkmcnt(0)
    ds_read_b64_tr_b16 v[144:145], v5 offset:21504
    ds_read_b64_tr_b16 v[146:147], v5 offset:23040
    ds_read_b64_tr_b16 v[148:149], v5 offset:21568
    ds_read_b64_tr_b16 v[150:151], v5 offset:23104
    ds_read_b64_tr_b16 v[152:153], v5 offset:21632
    ds_read_b64_tr_b16 v[154:155], v5 offset:23168
    ds_read_b64_tr_b16 v[156:157], v5 offset:36864
    ds_read_b64_tr_b16 v[158:159], v5 offset:38400
    ds_read_b64_tr_b16 v[160:161], v5 offset:36928
    ds_read_b64_tr_b16 v[162:163], v5 offset:38464
    ds_read_b64_tr_b16 v[164:165], v5 offset:36992
    ds_read_b64_tr_b16 v[166:167], v5 offset:38528
    s_add_u32 m0, s61, 1024
    s_add_u32 s54, s60, 6144
    buffer_load_dwordx4 v2, s[32:35], s54 offen lds
    s_setprio 1
    v_mfma_f32_32x32x16_bf16 v[80:95], v[120:123], v[96:99], v[192:207]
    v_cvt_pk_bf16_f32 v172, v248, v249
    v_cvt_pk_bf16_f32 v173, v250, v251
    v_rcp_f32 v176, v176
    v_rcp_f32 v177, v177
    v_mfma_f32_32x32x16_bf16 v[80:95], v[124:127], v[100:103], v[80:95]
    v_cvt_pk_bf16_f32 v174, v252, v253
    v_cvt_pk_bf16_f32 v175, v254, v255
    v_rcp_f32 v178, v178
    v_rcp_f32 v179, v179
    v_mfma_f32_32x32x16_bf16 v[80:95], v[128:131], v[104:107], v[80:95]
    v_rcp_f32 v180, v180
    v_rcp_f32 v181, v181
    v_rcp_f32 v182, v182
    v_mfma_f32_32x32x16_bf16 v[80:95], v[132:135], v[108:111], v[80:95]
    v_rcp_f32 v183, v183
    v_exp_f32 v184, v184
    v_exp_f32 v185, v185
    v_mfma_f32_32x32x16_bf16 v[80:95], v[136:139], v[112:115], v[80:95]
    v_exp_f32 v186, v186
    v_exp_f32 v187, v187
    v_exp_f32 v188, v188
    v_mfma_f32_32x32x16_bf16 v[80:95], v[140:143], v[116:119], v[80:95]
    v_exp_f32 v189, v189
    v_exp_f32 v190, v190
    v_exp_f32 v191, v191
    s_setprio 3
    v_add_f32 v184, 1.0, v184
    v_add_f32 v185, 1.0, v185
    v_add_f32 v186, 1.0, v186
    v_add_f32 v187, 1.0, v187
    v_add_f32 v188, 1.0, v188
    v_add_f32 v189, 1.0, v189
    v_add_f32 v190, 1.0, v190
    v_add_f32 v191, 1.0, v191
    v_mul_f32 v64, v64, v176
    v_mul_f32 v65, v65, v177
    v_mul_f32 v66, v66, v178
    v_mul_f32 v67, v67, v179
    v_mul_f32 v68, v68, v180
    v_mul_f32 v69, v69, v181
    v_mul_f32 v70, v70, v182
    v_mul_f32 v71, v71, v183
    v_fmaak_f32 v176, v80, v80, 0x409d30fc
    v_fmaak_f32 v177, v81, v81, 0x409d30fc
    v_fmaak_f32 v178, v82, v82, 0x409d30fc
    v_fmaak_f32 v179, v83, v83, 0x409d30fc
    v_fmaak_f32 v180, v84, v84, 0x409d30fc
    v_fmaak_f32 v181, v85, v85, 0x409d30fc
    v_fmaak_f32 v182, v86, v86, 0x409d30fc
    v_fmaak_f32 v183, v87, v87, 0x409d30fc
    v_mul_f32 v176, v80, v176
    v_mul_f32 v177, v81, v177
    v_mul_f32 v178, v82, v178
    v_mul_f32 v179, v83, v179
    v_mul_f32 v180, v84, v180
    v_mul_f32 v181, v85, v181
    v_mul_f32 v182, v86, v182
    v_mul_f32 v183, v87, v183
    s_waitcnt lgkmcnt(0)
    ds_read_b128 v[192:195], v6 offset:512
    ds_read_b128 v[196:199], v6 offset:544
    ds_read_b128 v[200:203], v6 offset:576
    ds_read_b128 v[204:207], v6 offset:608
    ds_read_b64_tr_b16 v[120:121], v4 offset:49152
    ds_read_b64_tr_b16 v[122:123], v4 offset:50176
    ds_read_b64_tr_b16 v[124:125], v4 offset:51200
    ds_read_b64_tr_b16 v[126:127], v4 offset:52224
    ds_read_b64_tr_b16 v[128:129], v4 offset:53248
    ds_read_b64_tr_b16 v[130:131], v4 offset:54272
    ds_read_b64_tr_b16 v[132:133], v4 offset:55296
    ds_read_b64_tr_b16 v[134:135], v4 offset:56320
    ds_read_b64_tr_b16 v[136:137], v4 offset:57344
    ds_read_b64_tr_b16 v[138:139], v4 offset:58368
    ds_read_b64_tr_b16 v[140:141], v4 offset:59392
    ds_read_b64_tr_b16 v[142:143], v4 offset:60416
    s_add_u32 m0, s61, 2048
    s_add_u32 s54, s60, 12288
    buffer_load_dwordx4 v2, s[32:35], s54 offen lds
    s_add_u32 s61, s61, 24576
    s_add_u32 s60, s60, 128
    s_setprio 1
    v_mfma_f32_32x32x16_bf16 v[16:31], v[144:147], v[172:175], v[16:31]
    v_cvt_pk_bf16_f32 v168, v64, v65
    v_cvt_pk_bf16_f32 v169, v66, v67
    v_rcp_f32 v184, v184
    v_rcp_f32 v185, v185
    v_mfma_f32_32x32x16_bf16 v[32:47], v[148:151], v[172:175], v[32:47]
    v_cvt_pk_bf16_f32 v170, v68, v69
    v_cvt_pk_bf16_f32 v171, v70, v71
    v_rcp_f32 v186, v186
    v_rcp_f32 v187, v187
    v_mfma_f32_32x32x16_bf16 v[48:63], v[152:155], v[172:175], v[48:63]
    v_rcp_f32 v188, v188
    v_rcp_f32 v189, v189
    v_rcp_f32 v190, v190
    v_mfma_f32_32x32x16_bf16 v[16:31], v[156:159], v[168:171], v[16:31]
    v_rcp_f32 v191, v191
    v_exp_f32 v176, v176
    v_exp_f32 v177, v177
    v_mfma_f32_32x32x16_bf16 v[32:47], v[160:163], v[168:171], v[32:47]
    v_exp_f32 v178, v178
    v_exp_f32 v179, v179
    v_exp_f32 v180, v180
    v_mfma_f32_32x32x16_bf16 v[48:63], v[164:167], v[168:171], v[48:63]
    v_exp_f32 v181, v181
    v_exp_f32 v182, v182
    v_exp_f32 v183, v183
    s_setprio 3
    v_add_f32 v176, 1.0, v176
    v_add_f32 v177, 1.0, v177
    v_add_f32 v178, 1.0, v178
    v_add_f32 v179, 1.0, v179
    v_add_f32 v180, 1.0, v180
    v_add_f32 v181, 1.0, v181
    v_add_f32 v182, 1.0, v182
    v_add_f32 v183, 1.0, v183
    v_mul_f32 v248, v72, v184
    v_mul_f32 v249, v73, v185
    v_mul_f32 v250, v74, v186
    v_mul_f32 v251, v75, v187
    v_mul_f32 v252, v76, v188
    v_mul_f32 v253, v77, v189
    v_mul_f32 v254, v78, v190
    v_mul_f32 v255, v79, v191
    v_fmaak_f32 v184, v88, v88, 0x409d30fc
    v_fmaak_f32 v185, v89, v89, 0x409d30fc
    v_fmaak_f32 v186, v90, v90, 0x409d30fc
    v_fmaak_f32 v187, v91, v91, 0x409d30fc
    v_fmaak_f32 v188, v92, v92, 0x409d30fc
    v_fmaak_f32 v189, v93, v93, 0x409d30fc
    v_fmaak_f32 v190, v94, v94, 0x409d30fc
    v_fmaak_f32 v191, v95, v95, 0x409d30fc
    v_mul_f32 v184, v88, v184
    v_mul_f32 v185, v89, v185
    v_mul_f32 v186, v90, v186
    v_mul_f32 v187, v91, v187
    v_mul_f32 v188, v92, v188
    v_mul_f32 v189, v93, v189
    v_mul_f32 v190, v94, v190
    v_mul_f32 v191, v95, v191
    s_waitcnt lgkmcnt(0)
    ds_read_b64_tr_b16 v[144:145], v5 offset:39936
    ds_read_b64_tr_b16 v[146:147], v5 offset:41472
    ds_read_b64_tr_b16 v[148:149], v5 offset:40000
    ds_read_b64_tr_b16 v[150:151], v5 offset:41536
    ds_read_b64_tr_b16 v[152:153], v5 offset:40064
    ds_read_b64_tr_b16 v[154:155], v5 offset:41600
    ds_read_b64_tr_b16 v[156:157], v5 offset:43008
    ds_read_b64_tr_b16 v[158:159], v5 offset:44544
    ds_read_b64_tr_b16 v[160:161], v5 offset:43072
    ds_read_b64_tr_b16 v[162:163], v5 offset:44608
    ds_read_b64_tr_b16 v[164:165], v5 offset:43136
    ds_read_b64_tr_b16 v[166:167], v5 offset:44672
    s_setprio 1
    v_mfma_f32_32x32x16_bf16 v[64:79], v[120:123], v[96:99], v[192:207]
    v_cvt_pk_bf16_f32 v172, v248, v249
    v_cvt_pk_bf16_f32 v173, v250, v251
    v_rcp_f32 v176, v176
    v_rcp_f32 v177, v177
    v_mfma_f32_32x32x16_bf16 v[64:79], v[124:127], v[100:103], v[64:79]
    v_cvt_pk_bf16_f32 v174, v252, v253
    v_cvt_pk_bf16_f32 v175, v254, v255
    v_rcp_f32 v178, v178
    v_rcp_f32 v179, v179
    v_mfma_f32_32x32x16_bf16 v[64:79], v[128:131], v[104:107], v[64:79]
    v_rcp_f32 v180, v180
    v_rcp_f32 v181, v181
    v_rcp_f32 v182, v182
    v_mfma_f32_32x32x16_bf16 v[64:79], v[132:135], v[108:111], v[64:79]
    v_rcp_f32 v183, v183
    v_exp_f32 v184, v184
    v_exp_f32 v185, v185
    v_mfma_f32_32x32x16_bf16 v[64:79], v[136:139], v[112:115], v[64:79]
    v_exp_f32 v186, v186
    v_exp_f32 v187, v187
    v_exp_f32 v188, v188
    v_mfma_f32_32x32x16_bf16 v[64:79], v[140:143], v[116:119], v[64:79]
    v_exp_f32 v189, v189
    v_exp_f32 v190, v190
    v_exp_f32 v191, v191
    s_setprio 3
    v_add_f32 v184, 1.0, v184
    v_add_f32 v185, 1.0, v185
    v_add_f32 v186, 1.0, v186
    v_add_f32 v187, 1.0, v187
    v_add_f32 v188, 1.0, v188
    v_add_f32 v189, 1.0, v189
    v_add_f32 v190, 1.0, v190
    v_add_f32 v191, 1.0, v191
    v_mul_f32 v80, v80, v176
    v_mul_f32 v81, v81, v177
    v_mul_f32 v82, v82, v178
    v_mul_f32 v83, v83, v179
    v_mul_f32 v84, v84, v180
    v_mul_f32 v85, v85, v181
    v_mul_f32 v86, v86, v182
    v_mul_f32 v87, v87, v183
    v_fmaak_f32 v176, v64, v64, 0x409d30fc
    v_fmaak_f32 v177, v65, v65, 0x409d30fc
    v_fmaak_f32 v178, v66, v66, 0x409d30fc
    v_fmaak_f32 v179, v67, v67, 0x409d30fc
    v_fmaak_f32 v180, v68, v68, 0x409d30fc
    v_fmaak_f32 v181, v69, v69, 0x409d30fc
    v_fmaak_f32 v182, v70, v70, 0x409d30fc
    v_fmaak_f32 v183, v71, v71, 0x409d30fc
    v_mul_f32 v176, v64, v176
    v_mul_f32 v177, v65, v177
    v_mul_f32 v178, v66, v178
    v_mul_f32 v179, v67, v179
    v_mul_f32 v180, v68, v180
    v_mul_f32 v181, v69, v181
    v_mul_f32 v182, v70, v182
    v_mul_f32 v183, v71, v183
    s_waitcnt lgkmcnt(0)
    ds_read_b128 v[192:195], v6 offset:640
    ds_read_b128 v[196:199], v6 offset:672
    ds_read_b128 v[200:203], v6 offset:704
    ds_read_b128 v[204:207], v6 offset:736
    ds_read_b64_tr_b16 v[120:121], v4 offset:49664
    ds_read_b64_tr_b16 v[122:123], v4 offset:50688
    ds_read_b64_tr_b16 v[124:125], v4 offset:51712
    ds_read_b64_tr_b16 v[126:127], v4 offset:52736
    ds_read_b64_tr_b16 v[128:129], v4 offset:53760
    ds_read_b64_tr_b16 v[130:131], v4 offset:54784
    ds_read_b64_tr_b16 v[132:133], v4 offset:55808
    ds_read_b64_tr_b16 v[134:135], v4 offset:56832
    ds_read_b64_tr_b16 v[136:137], v4 offset:57856
    ds_read_b64_tr_b16 v[138:139], v4 offset:58880
    ds_read_b64_tr_b16 v[140:141], v4 offset:59904
    ds_read_b64_tr_b16 v[142:143], v4 offset:60928
    s_waitcnt vmcnt(0)
    ds_write_b8 v14, v3
    s_add_u32 m0, s61, 0
    s_add_u32 s54, s60, 0
    buffer_load_dwordx4 v2, s[32:35], s54 offen lds
    s_setprio 1
    v_mfma_f32_32x32x16_bf16 v[16:31], v[144:147], v[172:175], v[16:31]
    v_cvt_pk_bf16_f32 v168, v80, v81
    v_cvt_pk_bf16_f32 v169, v82, v83
    v_rcp_f32 v184, v184
    v_rcp_f32 v185, v185
    v_mfma_f32_32x32x16_bf16 v[32:47], v[148:151], v[172:175], v[32:47]
    v_cvt_pk_bf16_f32 v170, v84, v85
    v_cvt_pk_bf16_f32 v171, v86, v87
    v_rcp_f32 v186, v186
    v_rcp_f32 v187, v187
    v_mfma_f32_32x32x16_bf16 v[48:63], v[152:155], v[172:175], v[48:63]
    v_rcp_f32 v188, v188
    v_rcp_f32 v189, v189
    v_rcp_f32 v190, v190
    v_mfma_f32_32x32x16_bf16 v[16:31], v[156:159], v[168:171], v[16:31]
    v_rcp_f32 v191, v191
    v_exp_f32 v176, v176
    v_exp_f32 v177, v177
    v_mfma_f32_32x32x16_bf16 v[32:47], v[160:163], v[168:171], v[32:47]
    v_exp_f32 v178, v178
    v_exp_f32 v179, v179
    v_exp_f32 v180, v180
    v_mfma_f32_32x32x16_bf16 v[48:63], v[164:167], v[168:171], v[48:63]
    v_exp_f32 v181, v181
    v_exp_f32 v182, v182
    v_exp_f32 v183, v183
    s_setprio 3
    v_add_f32 v176, 1.0, v176
    v_add_f32 v177, 1.0, v177
    v_add_f32 v178, 1.0, v178
    v_add_f32 v179, 1.0, v179
    v_add_f32 v180, 1.0, v180
    v_add_f32 v181, 1.0, v181
    v_add_f32 v182, 1.0, v182
    v_add_f32 v183, 1.0, v183
    v_mul_f32 v248, v88, v184
    v_mul_f32 v249, v89, v185
    v_mul_f32 v250, v90, v186
    v_mul_f32 v251, v91, v187
    v_mul_f32 v252, v92, v188
    v_mul_f32 v253, v93, v189
    v_mul_f32 v254, v94, v190
    v_mul_f32 v255, v95, v191
    v_fmaak_f32 v184, v72, v72, 0x409d30fc
    v_fmaak_f32 v185, v73, v73, 0x409d30fc
    v_fmaak_f32 v186, v74, v74, 0x409d30fc
    v_fmaak_f32 v187, v75, v75, 0x409d30fc
    v_fmaak_f32 v188, v76, v76, 0x409d30fc
    v_fmaak_f32 v189, v77, v77, 0x409d30fc
    v_fmaak_f32 v190, v78, v78, 0x409d30fc
    v_fmaak_f32 v191, v79, v79, 0x409d30fc
    v_mul_f32 v184, v72, v184
    v_mul_f32 v185, v73, v185
    v_mul_f32 v186, v74, v186
    v_mul_f32 v187, v75, v187
    v_mul_f32 v188, v76, v188
    v_mul_f32 v189, v77, v189
    v_mul_f32 v190, v78, v190
    v_mul_f32 v191, v79, v191
    v_add_u32 v3, 1, v3
    s_waitcnt lgkmcnt(0)
    ds_read_b64_tr_b16 v[144:145], v5 offset:46080
    ds_read_b64_tr_b16 v[146:147], v5 offset:47616
    ds_read_b64_tr_b16 v[148:149], v5 offset:46144
    ds_read_b64_tr_b16 v[150:151], v5 offset:47680
    ds_read_b64_tr_b16 v[152:153], v5 offset:46208
    ds_read_b64_tr_b16 v[154:155], v5 offset:47744
    ds_read_b64_tr_b16 v[156:157], v5 offset:61440
    ds_read_b64_tr_b16 v[158:159], v5 offset:62976
    ds_read_b64_tr_b16 v[160:161], v5 offset:61504
    ds_read_b64_tr_b16 v[162:163], v5 offset:63040
    ds_read_b64_tr_b16 v[164:165], v5 offset:61568
    ds_read_b64_tr_b16 v[166:167], v5 offset:63104
    s_add_u32 m0, s61, 1024
    s_add_u32 s54, s60, 6144
    buffer_load_dwordx4 v2, s[32:35], s54 offen lds
    ds_read_b32 v0, v15 offset:0
    s_setprio 1
    v_mfma_f32_32x32x16_bf16 v[80:95], v[120:123], v[96:99], v[192:207]
    v_cvt_pk_bf16_f32 v172, v248, v249
    v_cvt_pk_bf16_f32 v173, v250, v251
    v_rcp_f32 v176, v176
    v_rcp_f32 v177, v177
    v_mfma_f32_32x32x16_bf16 v[80:95], v[124:127], v[100:103], v[80:95]
    v_cvt_pk_bf16_f32 v174, v252, v253
    v_cvt_pk_bf16_f32 v175, v254, v255
    v_rcp_f32 v178, v178
    v_rcp_f32 v179, v179
    v_mfma_f32_32x32x16_bf16 v[80:95], v[128:131], v[104:107], v[80:95]
    v_rcp_f32 v180, v180
    v_rcp_f32 v181, v181
    v_rcp_f32 v182, v182
    v_mfma_f32_32x32x16_bf16 v[80:95], v[132:135], v[108:111], v[80:95]
    v_rcp_f32 v183, v183
    v_exp_f32 v184, v184
    v_exp_f32 v185, v185
    v_mfma_f32_32x32x16_bf16 v[80:95], v[136:139], v[112:115], v[80:95]
    v_exp_f32 v186, v186
    v_exp_f32 v187, v187
    v_exp_f32 v188, v188
    v_mfma_f32_32x32x16_bf16 v[80:95], v[140:143], v[116:119], v[80:95]
    v_exp_f32 v189, v189
    v_exp_f32 v190, v190
    v_exp_f32 v191, v191
    s_setprio 3
    v_add_f32 v184, 1.0, v184
    v_add_f32 v185, 1.0, v185
    v_add_f32 v186, 1.0, v186
    v_add_f32 v187, 1.0, v187
    v_add_f32 v188, 1.0, v188
    v_add_f32 v189, 1.0, v189
    v_add_f32 v190, 1.0, v190
    v_add_f32 v191, 1.0, v191
    v_mul_f32 v64, v64, v176
    v_mul_f32 v65, v65, v177
    v_mul_f32 v66, v66, v178
    v_mul_f32 v67, v67, v179
    v_mul_f32 v68, v68, v180
    v_mul_f32 v69, v69, v181
    v_mul_f32 v70, v70, v182
    v_mul_f32 v71, v71, v183
    v_fmaak_f32 v176, v80, v80, 0x409d30fc
    v_fmaak_f32 v177, v81, v81, 0x409d30fc
    v_fmaak_f32 v178, v82, v82, 0x409d30fc
    v_fmaak_f32 v179, v83, v83, 0x409d30fc
    v_fmaak_f32 v180, v84, v84, 0x409d30fc
    v_fmaak_f32 v181, v85, v85, 0x409d30fc
    v_fmaak_f32 v182, v86, v86, 0x409d30fc
    v_fmaak_f32 v183, v87, v87, 0x409d30fc
    v_mul_f32 v176, v80, v176
    v_mul_f32 v177, v81, v177
    v_mul_f32 v178, v82, v178
    v_mul_f32 v179, v83, v179
    v_mul_f32 v180, v84, v180
    v_mul_f32 v181, v85, v181
    v_mul_f32 v182, v86, v182
    v_mul_f32 v183, v87, v183
    v_add_u32 v4, 49152, v4
    v_add_u32 v5, 49152, v5
    s_waitcnt lgkmcnt(0)
    v_readfirstlane_b32 s54, v0
    s_nop 0
    s_add_u32 s54, s54, 0x79797979
    s_andn2_b32 s54, 0x80808080, s54
    s_cbranch_scc0 L_needE10_ok
L_needE10:
    ds_read_b32 v0, v15 offset:0
    s_waitcnt lgkmcnt(0)
    v_readfirstlane_b32 s54, v0
    s_nop 0
    s_add_u32 s54, s54, 0x79797979
    s_andn2_b32 s54, 0x80808080, s54
    s_cbranch_scc1 L_needE10
L_needE10_ok:
    ds_read_b128 v[192:195], v6 offset:768
    ds_read_b128 v[196:199], v6 offset:800
    ds_read_b128 v[200:203], v6 offset:832
    ds_read_b128 v[204:207], v6 offset:864
    ds_read_b64_tr_b16 v[120:121], v4 offset:24576
    ds_read_b64_tr_b16 v[122:123], v4 offset:25600
    ds_read_b64_tr_b16 v[124:125], v4 offset:26624
    ds_read_b64_tr_b16 v[126:127], v4 offset:27648
    ds_read_b64_tr_b16 v[128:129], v4 offset:28672
    ds_read_b64_tr_b16 v[130:131], v4 offset:29696
    ds_read_b64_tr_b16 v[132:133], v4 offset:30720
    ds_read_b64_tr_b16 v[134:135], v4 offset:31744
    ds_read_b64_tr_b16 v[136:137], v4 offset:32768
    ds_read_b64_tr_b16 v[138:139], v4 offset:33792
    ds_read_b64_tr_b16 v[140:141], v4 offset:34816
    ds_read_b64_tr_b16 v[142:143], v4 offset:35840
    s_add_u32 m0, s61, 2048
    s_add_u32 s54, s60, 12288
    buffer_load_dwordx4 v2, s[32:35], s54 offen lds
    s_add_u32 s61, s61, 24576
    s_add_u32 s60, s60, 128
    s_setprio 1
    v_mfma_f32_32x32x16_bf16 v[16:31], v[144:147], v[172:175], v[16:31]
    v_cvt_pk_bf16_f32 v168, v64, v65
    v_cvt_pk_bf16_f32 v169, v66, v67
    v_rcp_f32 v184, v184
    v_rcp_f32 v185, v185
    v_mfma_f32_32x32x16_bf16 v[32:47], v[148:151], v[172:175], v[32:47]
    v_cvt_pk_bf16_f32 v170, v68, v69
    v_cvt_pk_bf16_f32 v171, v70, v71
    v_rcp_f32 v186, v186
    v_rcp_f32 v187, v187
    v_mfma_f32_32x32x16_bf16 v[48:63], v[152:155], v[172:175], v[48:63]
    v_rcp_f32 v188, v188
    v_rcp_f32 v189, v189
    v_rcp_f32 v190, v190
    v_mfma_f32_32x32x16_bf16 v[16:31], v[156:159], v[168:171], v[16:31]
    v_rcp_f32 v191, v191
    v_exp_f32 v176, v176
    v_exp_f32 v177, v177
    v_mfma_f32_32x32x16_bf16 v[32:47], v[160:163], v[168:171], v[32:47]
    v_exp_f32 v178, v178
    v_exp_f32 v179, v179
    v_exp_f32 v180, v180
    v_mfma_f32_32x32x16_bf16 v[48:63], v[164:167], v[168:171], v[48:63]
    v_exp_f32 v181, v181
    v_exp_f32 v182, v182
    v_exp_f32 v183, v183
    s_setprio 3
    v_add_f32 v176, 1.0, v176
    v_add_f32 v177, 1.0, v177
    v_add_f32 v178, 1.0, v178
    v_add_f32 v179, 1.0, v179
    v_add_f32 v180, 1.0, v180
    v_add_f32 v181, 1.0, v181
    v_add_f32 v182, 1.0, v182
    v_add_f32 v183, 1.0, v183
    v_mul_f32 v248, v72, v184
    v_mul_f32 v249, v73, v185
    v_mul_f32 v250, v74, v186
    v_mul_f32 v251, v75, v187
    v_mul_f32 v252, v76, v188
    v_mul_f32 v253, v77, v189
    v_mul_f32 v254, v78, v190
    v_mul_f32 v255, v79, v191
    v_fmaak_f32 v184, v88, v88, 0x409d30fc
    v_fmaak_f32 v185, v89, v89, 0x409d30fc
    v_fmaak_f32 v186, v90, v90, 0x409d30fc
    v_fmaak_f32 v187, v91, v91, 0x409d30fc
    v_fmaak_f32 v188, v92, v92, 0x409d30fc
    v_fmaak_f32 v189, v93, v93, 0x409d30fc
    v_fmaak_f32 v190, v94, v94, 0x409d30fc
    v_fmaak_f32 v191, v95, v95, 0x409d30fc
    v_mul_f32 v184, v88, v184
    v_mul_f32 v185, v89, v185
    v_mul_f32 v186, v90, v186
    v_mul_f32 v187, v91, v187
    v_mul_f32 v188, v92, v188
    v_mul_f32 v189, v93, v189
    v_mul_f32 v190, v94, v190
    v_mul_f32 v191, v95, v191
    s_waitcnt lgkmcnt(0)
    ds_read_b64_tr_b16 v[144:145], v5 offset:15360
    ds_read_b64_tr_b16 v[146:147], v5 offset:16896
    ds_read_b64_tr_b16 v[148:149], v5 offset:15424
    ds_read_b64_tr_b16 v[150:151], v5 offset:16960
    ds_read_b64_tr_b16 v[152:153], v5 offset:15488
    ds_read_b64_tr_b16 v[154:155], v5 offset:17024
    ds_read_b64_tr_b16 v[156:157], v5 offset:18432
    ds_read_b64_tr_b16 v[158:159], v5 offset:19968
    ds_read_b64_tr_b16 v[160:161], v5 offset:18496
    ds_read_b64_tr_b16 v[162:163], v5 offset:20032
    ds_read_b64_tr_b16 v[164:165], v5 offset:18560
    ds_read_b64_tr_b16 v[166:167], v5 offset:20096
    s_setprio 1
    v_mfma_f32_32x32x16_bf16 v[64:79], v[120:123], v[96:99], v[192:207]
    v_cvt_pk_bf16_f32 v172, v248, v249
    v_cvt_pk_bf16_f32 v173, v250, v251
    v_rcp_f32 v176, v176
    v_rcp_f32 v177, v177
    v_mfma_f32_32x32x16_bf16 v[64:79], v[124:127], v[100:103], v[64:79]
    v_cvt_pk_bf16_f32 v174, v252, v253
    v_cvt_pk_bf16_f32 v175, v254, v255
    v_rcp_f32 v178, v178
    v_rcp_f32 v179, v179
    v_mfma_f32_32x32x16_bf16 v[64:79], v[128:131], v[104:107], v[64:79]
    v_rcp_f32 v180, v180
    v_rcp_f32 v181, v181
    v_rcp_f32 v182, v182
    v_mfma_f32_32x32x16_bf16 v[64:79], v[132:135], v[108:111], v[64:79]
    v_rcp_f32 v183, v183
    v_exp_f32 v184, v184
    v_exp_f32 v185, v185
    v_mfma_f32_32x32x16_bf16 v[64:79], v[136:139], v[112:115], v[64:79]
    v_exp_f32 v186, v186
    v_exp_f32 v187, v187
    v_exp_f32 v188, v188
    v_mfma_f32_32x32x16_bf16 v[64:79], v[140:143], v[116:119], v[64:79]
    v_exp_f32 v189, v189
    v_exp_f32 v190, v190
    v_exp_f32 v191, v191
    s_setprio 3
    v_add_f32 v184, 1.0, v184
    v_add_f32 v185, 1.0, v185
    v_add_f32 v186, 1.0, v186
    v_add_f32 v187, 1.0, v187
    v_add_f32 v188, 1.0, v188
    v_add_f32 v189, 1.0, v189
    v_add_f32 v190, 1.0, v190
    v_add_f32 v191, 1.0, v191
    v_mul_f32 v80, v80, v176
    v_mul_f32 v81, v81, v177
    v_mul_f32 v82, v82, v178
    v_mul_f32 v83, v83, v179
    v_mul_f32 v84, v84, v180
    v_mul_f32 v85, v85, v181
    v_mul_f32 v86, v86, v182
    v_mul_f32 v87, v87, v183
    v_fmaak_f32 v176, v64, v64, 0x409d30fc
    v_fmaak_f32 v177, v65, v65, 0x409d30fc
    v_fmaak_f32 v178, v66, v66, 0x409d30fc
    v_fmaak_f32 v179, v67, v67, 0x409d30fc
    v_fmaak_f32 v180, v68, v68, 0x409d30fc
    v_fmaak_f32 v181, v69, v69, 0x409d30fc
    v_fmaak_f32 v182, v70, v70, 0x409d30fc
    v_fmaak_f32 v183, v71, v71, 0x409d30fc
    v_mul_f32 v176, v64, v176
    v_mul_f32 v177, v65, v177
    v_mul_f32 v178, v66, v178
    v_mul_f32 v179, v67, v179
    v_mul_f32 v180, v68, v180
    v_mul_f32 v181, v69, v181
    v_mul_f32 v182, v70, v182
    v_mul_f32 v183, v71, v183
    s_waitcnt lgkmcnt(0)
    ds_read_b128 v[192:195], v6 offset:896
    ds_read_b128 v[196:199], v6 offset:928
    ds_read_b128 v[200:203], v6 offset:960
    ds_read_b128 v[204:207], v6 offset:992
    ds_read_b64_tr_b16 v[120:121], v4 offset:25088
    ds_read_b64_tr_b16 v[122:123], v4 offset:26112
    ds_read_b64_tr_b16 v[124:125], v4 offset:27136
    ds_read_b64_tr_b16 v[126:127], v4 offset:28160
    ds_read_b64_tr_b16 v[128:129], v4 offset:29184
    ds_read_b64_tr_b16 v[130:131], v4 offset:30208
    ds_read_b64_tr_b16 v[132:133], v4 offset:31232
    ds_read_b64_tr_b16 v[134:135], v4 offset:32256
    ds_read_b64_tr_b16 v[136:137], v4 offset:33280
    ds_read_b64_tr_b16 v[138:139], v4 offset:34304
    ds_read_b64_tr_b16 v[140:141], v4 offset:35328
    ds_read_b64_tr_b16 v[142:143], v4 offset:36352
    s_waitcnt vmcnt(0)
    ds_write_b8 v14, v3
    ds_read_b32 v0, v15 offset:4
    s_setprio 1
    v_mfma_f32_32x32x16_bf16 v[16:31], v[144:147], v[172:175], v[16:31]
    v_cvt_pk_bf16_f32 v168, v80, v81
    v_cvt_pk_bf16_f32 v169, v82, v83
    v_rcp_f32 v184, v184
    v_rcp_f32 v185, v185
    v_mfma_f32_32x32x16_bf16 v[32:47], v[148:151], v[172:175], v[32:47]
    v_cvt_pk_bf16_f32 v170, v84, v85
    v_cvt_pk_bf16_f32 v171, v86, v87
    v_rcp_f32 v186, v186
    v_rcp_f32 v187, v187
    v_mfma_f32_32x32x16_bf16 v[48:63], v[152:155], v[172:175], v[48:63]
    v_rcp_f32 v188, v188
    v_rcp_f32 v189, v189
    v_rcp_f32 v190, v190
    v_mfma_f32_32x32x16_bf16 v[16:31], v[156:159], v[168:171], v[16:31]
    v_rcp_f32 v191, v191
    v_exp_f32 v176, v176
    v_exp_f32 v177, v177
    v_mfma_f32_32x32x16_bf16 v[32:47], v[160:163], v[168:171], v[32:47]
    v_exp_f32 v178, v178
    v_exp_f32 v179, v179
    v_exp_f32 v180, v180
    v_mfma_f32_32x32x16_bf16 v[48:63], v[164:167], v[168:171], v[48:63]
    v_exp_f32 v181, v181
    v_exp_f32 v182, v182
    v_exp_f32 v183, v183
    s_setprio 3
    v_add_f32 v176, 1.0, v176
    v_add_f32 v177, 1.0, v177
    v_add_f32 v178, 1.0, v178
    v_add_f32 v179, 1.0, v179
    v_add_f32 v180, 1.0, v180
    v_add_f32 v181, 1.0, v181
    v_add_f32 v182, 1.0, v182
    v_add_f32 v183, 1.0, v183
    v_mul_f32 v248, v88, v184
    v_mul_f32 v249, v89, v185
    v_mul_f32 v250, v90, v186
    v_mul_f32 v251, v91, v187
    v_mul_f32 v252, v92, v188
    v_mul_f32 v253, v93, v189
    v_mul_f32 v254, v94, v190
    v_mul_f32 v255, v95, v191
    v_fmaak_f32 v184, v72, v72, 0x409d30fc
    v_fmaak_f32 v185, v73, v73, 0x409d30fc
    v_fmaak_f32 v186, v74, v74, 0x409d30fc
    v_fmaak_f32 v187, v75, v75, 0x409d30fc
    v_fmaak_f32 v188, v76, v76, 0x409d30fc
    v_fmaak_f32 v189, v77, v77, 0x409d30fc
    v_fmaak_f32 v190, v78, v78, 0x409d30fc
    v_fmaak_f32 v191, v79, v79, 0x409d30fc
    v_mul_f32 v184, v72, v184
    v_mul_f32 v185, v73, v185
    v_mul_f32 v186, v74, v186
    v_mul_f32 v187, v75, v187
    v_mul_f32 v188, v76, v188
    v_mul_f32 v189, v77, v189
    v_mul_f32 v190, v78, v190
    v_mul_f32 v191, v79, v191
    v_add_u32 v3, 1, v3
    s_waitcnt lgkmcnt(0)
    v_readfirstlane_b32 s54, v0
    s_nop 0
    s_add_u32 s54, s54, 0x79797979
    s_andn2_b32 s54, 0x80808080, s54
    s_cbranch_scc0 L_needE13_ok
L_needE13:
    ds_read_b32 v0, v15 offset:4
    s_waitcnt lgkmcnt(0)
    v_readfirstlane_b32 s54, v0
    s_nop 0
    s_add_u32 s54, s54, 0x79797979
    s_andn2_b32 s54, 0x80808080, s54
    s_cbranch_scc1 L_needE13
L_needE13_ok:
    ds_read_b64_tr_b16 v[144:145], v5 offset:21504
    ds_read_b64_tr_b16 v[146:147], v5 offset:23040
    ds_read_b64_tr_b16 v[148:149], v5 offset:21568
    ds_read_b64_tr_b16 v[150:151], v5 offset:23104
    ds_read_b64_tr_b16 v[152:153], v5 offset:21632
    ds_read_b64_tr_b16 v[154:155], v5 offset:23168
    ds_read_b64_tr_b16 v[156:157], v5 offset:36864
    ds_read_b64_tr_b16 v[158:159], v5 offset:38400
    ds_read_b64_tr_b16 v[160:161], v5 offset:36928
    ds_read_b64_tr_b16 v[162:163], v5 offset:38464
    ds_read_b64_tr_b16 v[164:165], v5 offset:36992
    ds_read_b64_tr_b16 v[166:167], v5 offset:38528
    ds_read_b32 v0, v15 offset:0
    s_setprio 1
    v_mfma_f32_32x32x16_bf16 v[80:95], v[120:123], v[96:99], v[192:207]
    v_cvt_pk_bf16_f32 v172, v248, v249
    v_cvt_pk_bf16_f32 v173, v250, v251
    v_rcp_f32 v176, v176
    v_rcp_f32 v177, v177
    v_mfma_f32_32x32x16_bf16 v[80:95], v[124:127], v[100:103], v[80:95]
    v_cvt_pk_bf16_f32 v174, v252, v253
    v_cvt_pk_bf16_f32 v175, v254, v255
    v_rcp_f32 v178, v178
    v_rcp_f32 v179, v179
    v_mfma_f32_32x32x16_bf16 v[80:95], v[128:131], v[104:107], v[80:95]
    v_rcp_f32 v180, v180
    v_rcp_f32 v181, v181
    v_rcp_f32 v182, v182
    v_mfma_f32_32x32x16_bf16 v[80:95], v[132:135], v[108:111], v[80:95]
    v_rcp_f32 v183, v183
    v_exp_f32 v184, v184
    v_exp_f32 v185, v185
    v_mfma_f32_32x32x16_bf16 v[80:95], v[136:139], v[112:115], v[80:95]
    v_exp_f32 v186, v186
    v_exp_f32 v187, v187
    v_exp_f32 v188, v188
    v_mfma_f32_32x32x16_bf16 v[80:95], v[140:143], v[116:119], v[80:95]
    v_exp_f32 v189, v189
    v_exp_f32 v190, v190
    v_exp_f32 v191, v191
    s_setprio 3
    v_add_f32 v184, 1.0, v184
    v_add_f32 v185, 1.0, v185
    v_add_f32 v186, 1.0, v186
    v_add_f32 v187, 1.0, v187
    v_add_f32 v188, 1.0, v188
    v_add_f32 v189, 1.0, v189
    v_add_f32 v190, 1.0, v190
    v_add_f32 v191, 1.0, v191
    v_mul_f32 v64, v64, v176
    v_mul_f32 v65, v65, v177
    v_mul_f32 v66, v66, v178
    v_mul_f32 v67, v67, v179
    v_mul_f32 v68, v68, v180
    v_mul_f32 v69, v69, v181
    v_mul_f32 v70, v70, v182
    v_mul_f32 v71, v71, v183
    v_fmaak_f32 v176, v80, v80, 0x409d30fc
    v_fmaak_f32 v177, v81, v81, 0x409d30fc
    v_fmaak_f32 v178, v82, v82, 0x409d30fc
    v_fmaak_f32 v179, v83, v83, 0x409d30fc
    v_fmaak_f32 v180, v84, v84, 0x409d30fc
    v_fmaak_f32 v181, v85, v85, 0x409d30fc
    v_fmaak_f32 v182, v86, v86, 0x409d30fc
    v_fmaak_f32 v183, v87, v87, 0x409d30fc
    v_mul_f32 v176, v80, v176
    v_mul_f32 v177, v81, v177
    v_mul_f32 v178, v82, v178
    v_mul_f32 v179, v83, v179
    v_mul_f32 v180, v84, v180
    v_mul_f32 v181, v85, v181
    v_mul_f32 v182, v86, v182
    v_mul_f32 v183, v87, v183
    s_waitcnt lgkmcnt(0)
    v_readfirstlane_b32 s54, v0
    s_nop 0
    s_add_u32 s54, s54, 0x78787878
    s_andn2_b32 s54, 0x80808080, s54
    s_cbranch_scc0 L_needE14_ok
L_needE14:
    ds_read_b32 v0, v15 offset:0
    s_waitcnt lgkmcnt(0)
    v_readfirstlane_b32 s54, v0
    s_nop 0
    s_add_u32 s54, s54, 0x78787878
    s_andn2_b32 s54, 0x80808080, s54
    s_cbranch_scc1 L_needE14
L_needE14_ok:
    ds_read_b128 v[192:195], v6 offset:1024
    ds_read_b128 v[196:199], v6 offset:1056
    ds_read_b128 v[200:203], v6 offset:1088
    ds_read_b128 v[204:207], v6 offset:1120
    ds_read_b64_tr_b16 v[120:121], v4 offset:49152
    ds_read_b64_tr_b16 v[122:123], v4 offset:50176
    ds_read_b64_tr_b16 v[124:125], v4 offset:51200
    ds_read_b64_tr_b16 v[126:127], v4 offset:52224
    ds_read_b64_tr_b16 v[128:129], v4 offset:53248
    ds_read_b64_tr_b16 v[130:131], v4 offset:54272
    ds_read_b64_tr_b16 v[132:133], v4 offset:55296
    ds_read_b64_tr_b16 v[134:135], v4 offset:56320
    ds_read_b64_tr_b16 v[136:137], v4 offset:57344
    ds_read_b64_tr_b16 v[138:139], v4 offset:58368
    ds_read_b64_tr_b16 v[140:141], v4 offset:59392
    ds_read_b64_tr_b16 v[142:143], v4 offset:60416
    s_setprio 1
    v_mfma_f32_32x32x16_bf16 v[16:31], v[144:147], v[172:175], v[16:31]
    v_cvt_pk_bf16_f32 v168, v64, v65
    v_cvt_pk_bf16_f32 v169, v66, v67
    v_rcp_f32 v184, v184
    v_rcp_f32 v185, v185
    v_mfma_f32_32x32x16_bf16 v[32:47], v[148:151], v[172:175], v[32:47]
    v_cvt_pk_bf16_f32 v170, v68, v69
    v_cvt_pk_bf16_f32 v171, v70, v71
    v_rcp_f32 v186, v186
    v_rcp_f32 v187, v187
    v_mfma_f32_32x32x16_bf16 v[48:63], v[152:155], v[172:175], v[48:63]
    v_rcp_f32 v188, v188
    v_rcp_f32 v189, v189
    v_rcp_f32 v190, v190
    v_mfma_f32_32x32x16_bf16 v[16:31], v[156:159], v[168:171], v[16:31]
    v_rcp_f32 v191, v191
    v_exp_f32 v176, v176
    v_exp_f32 v177, v177
    v_mfma_f32_32x32x16_bf16 v[32:47], v[160:163], v[168:171], v[32:47]
    v_exp_f32 v178, v178
    v_exp_f32 v179, v179
    v_exp_f32 v180, v180
    v_mfma_f32_32x32x16_bf16 v[48:63], v[164:167], v[168:171], v[48:63]
    v_exp_f32 v181, v181
    v_exp_f32 v182, v182
    v_exp_f32 v183, v183
    s_setprio 3
    v_add_f32 v176, 1.0, v176
    v_add_f32 v177, 1.0, v177
    v_add_f32 v178, 1.0, v178
    v_add_f32 v179, 1.0, v179
    v_add_f32 v180, 1.0, v180
    v_add_f32 v181, 1.0, v181
    v_add_f32 v182, 1.0, v182
    v_add_f32 v183, 1.0, v183
    v_mul_f32 v248, v72, v184
    v_mul_f32 v249, v73, v185
    v_mul_f32 v250, v74, v186
    v_mul_f32 v251, v75, v187
    v_mul_f32 v252, v76, v188
    v_mul_f32 v253, v77, v189
    v_mul_f32 v254, v78, v190
    v_mul_f32 v255, v79, v191
    v_fmaak_f32 v184, v88, v88, 0x409d30fc
    v_fmaak_f32 v185, v89, v89, 0x409d30fc
    v_fmaak_f32 v186, v90, v90, 0x409d30fc
    v_fmaak_f32 v187, v91, v91, 0x409d30fc
    v_fmaak_f32 v188, v92, v92, 0x409d30fc
    v_fmaak_f32 v189, v93, v93, 0x409d30fc
    v_fmaak_f32 v190, v94, v94, 0x409d30fc
    v_fmaak_f32 v191, v95, v95, 0x409d30fc
    v_mul_f32 v184, v88, v184
    v_mul_f32 v185, v89, v185
    v_mul_f32 v186, v90, v186
    v_mul_f32 v187, v91, v187
    v_mul_f32 v188, v92, v188
    v_mul_f32 v189, v93, v189
    v_mul_f32 v190, v94, v190
    v_mul_f32 v191, v95, v191
    s_waitcnt lgkmcnt(0)
    ds_read_b64_tr_b16 v[144:145], v5 offset:39936
    ds_read_b64_tr_b16 v[146:147], v5 offset:41472
    ds_read_b64_tr_b16 v[148:149], v5 offset:40000
    ds_read_b64_tr_b16 v[150:151], v5 offset:41536
    ds_read_b64_tr_b16 v[152:153], v5 offset:40064
    ds_read_b64_tr_b16 v[154:155], v5 offset:41600
    ds_read_b64_tr_b16 v[156:157], v5 offset:43008
    ds_read_b64_tr_b16 v[158:159], v5 offset:44544
    ds_read_b64_tr_b16 v[160:161], v5 offset:43072
    ds_read_b64_tr_b16 v[162:163], v5 offset:44608
    ds_read_b64_tr_b16 v[164:165], v5 offset:43136
    ds_read_b64_tr_b16 v[166:167], v5 offset:44672
    s_setprio 1
    v_mfma_f32_32x32x16_bf16 v[64:79], v[120:123], v[96:99], v[192:207]
    v_cvt_pk_bf16_f32 v172, v248, v249
    v_cvt_pk_bf16_f32 v173, v250, v251
    v_rcp_f32 v176, v176
    v_rcp_f32 v177, v177
    v_mfma_f32_32x32x16_bf16 v[64:79], v[124:127], v[100:103], v[64:79]
    v_cvt_pk_bf16_f32 v174, v252, v253
    v_cvt_pk_bf16_f32 v175, v254, v255
    v_rcp_f32 v178, v178
    v_rcp_f32 v179, v179
    v_mfma_f32_32x32x16_bf16 v[64:79], v[128:131], v[104:107], v[64:79]
    v_rcp_f32 v180, v180
    v_rcp_f32 v181, v181
    v_rcp_f32 v182, v182
    v_mfma_f32_32x32x16_bf16 v[64:79], v[132:135], v[108:111], v[64:79]
    v_rcp_f32 v183, v183
    v_exp_f32 v184, v184
    v_exp_f32 v185, v185
    v_mfma_f32_32x32x16_bf16 v[64:79], v[136:139], v[112:115], v[64:79]
    v_exp_f32 v186, v186
    v_exp_f32 v187, v187
    v_exp_f32 v188, v188
    v_mfma_f32_32x32x16_bf16 v[64:79], v[140:143], v[116:119], v[64:79]
    v_exp_f32 v189, v189
    v_exp_f32 v190, v190
    v_exp_f32 v191, v191
    s_setprio 3
    v_add_f32 v184, 1.0, v184
    v_add_f32 v185, 1.0, v185
    v_add_f32 v186, 1.0, v186
    v_add_f32 v187, 1.0, v187
    v_add_f32 v188, 1.0, v188
    v_add_f32 v189, 1.0, v189
    v_add_f32 v190, 1.0, v190
    v_add_f32 v191, 1.0, v191
    v_mul_f32 v80, v80, v176
    v_mul_f32 v81, v81, v177
    v_mul_f32 v82, v82, v178
    v_mul_f32 v83, v83, v179
    v_mul_f32 v84, v84, v180
    v_mul_f32 v85, v85, v181
    v_mul_f32 v86, v86, v182
    v_mul_f32 v87, v87, v183
    v_fmaak_f32 v176, v64, v64, 0x409d30fc
    v_fmaak_f32 v177, v65, v65, 0x409d30fc
    v_fmaak_f32 v178, v66, v66, 0x409d30fc
    v_fmaak_f32 v179, v67, v67, 0x409d30fc
    v_fmaak_f32 v180, v68, v68, 0x409d30fc
    v_fmaak_f32 v181, v69, v69, 0x409d30fc
    v_fmaak_f32 v182, v70, v70, 0x409d30fc
    v_fmaak_f32 v183, v71, v71, 0x409d30fc
    v_mul_f32 v176, v64, v176
    v_mul_f32 v177, v65, v177
    v_mul_f32 v178, v66, v178
    v_mul_f32 v179, v67, v179
    v_mul_f32 v180, v68, v180
    v_mul_f32 v181, v69, v181
    v_mul_f32 v182, v70, v182
    v_mul_f32 v183, v71, v183
    s_waitcnt lgkmcnt(0)
    ds_read_b128 v[192:195], v6 offset:1152
    ds_read_b128 v[196:199], v6 offset:1184
    ds_read_b128 v[200:203], v6 offset:1216
    ds_read_b128 v[204:207], v6 offset:1248
    ds_read_b64_tr_b16 v[120:121], v4 offset:49664
    ds_read_b64_tr_b16 v[122:123], v4 offset:50688
    ds_read_b64_tr_b16 v[124:125], v4 offset:51712
    ds_read_b64_tr_b16 v[126:127], v4 offset:52736
    ds_read_b64_tr_b16 v[128:129], v4 offset:53760
    ds_read_b64_tr_b16 v[130:131], v4 offset:54784
    ds_read_b64_tr_b16 v[132:133], v4 offset:55808
    ds_read_b64_tr_b16 v[134:135], v4 offset:56832
    ds_read_b64_tr_b16 v[136:137], v4 offset:57856
    ds_read_b64_tr_b16 v[138:139], v4 offset:58880
    ds_read_b64_tr_b16 v[140:141], v4 offset:59904
    ds_read_b64_tr_b16 v[142:143], v4 offset:60928
    ds_read_b32 v0, v15 offset:4
    s_setprio 1
    v_mfma_f32_32x32x16_bf16 v[16:31], v[144:147], v[172:175], v[16:31]
    v_cvt_pk_bf16_f32 v168, v80, v81
    v_cvt_pk_bf16_f32 v169, v82, v83
    v_rcp_f32 v184, v184
    v_rcp_f32 v185, v185
    v_mfma_f32_32x32x16_bf16 v[32:47], v[148:151], v[172:175], v[32:47]
    v_cvt_pk_bf16_f32 v170, v84, v85
    v_cvt_pk_bf16_f32 v171, v86, v87
    v_rcp_f32 v186, v186
    v_rcp_f32 v187, v187
    v_mfma_f32_32x32x16_bf16 v[48:63], v[152:155], v[172:175], v[48:63]
    v_rcp_f32 v188, v188
    v_rcp_f32 v189, v189
    v_rcp_f32 v190, v190
    v_mfma_f32_32x32x16_bf16 v[16:31], v[156:159], v[168:171], v[16:31]
    v_rcp_f32 v191, v191
    v_exp_f32 v176, v176
    v_exp_f32 v177, v177
    v_mfma_f32_32x32x16_bf16 v[32:47], v[160:163], v[168:171], v[32:47]
    v_exp_f32 v178, v178
    v_exp_f32 v179, v179
    v_exp_f32 v180, v180
    v_mfma_f32_32x32x16_bf16 v[48:63], v[164:167], v[168:171], v[48:63]
    v_exp_f32 v181, v181
    v_exp_f32 v182, v182
    v_exp_f32 v183, v183
    s_setprio 3
    v_add_f32 v176, 1.0, v176
    v_add_f32 v177, 1.0, v177
    v_add_f32 v178, 1.0, v178
    v_add_f32 v179, 1.0, v179
    v_add_f32 v180, 1.0, v180
    v_add_f32 v181, 1.0, v181
    v_add_f32 v182, 1.0, v182
    v_add_f32 v183, 1.0, v183
    v_mul_f32 v248, v88, v184
    v_mul_f32 v249, v89, v185
    v_mul_f32 v250, v90, v186
    v_mul_f32 v251, v91, v187
    v_mul_f32 v252, v92, v188
    v_mul_f32 v253, v93, v189
    v_mul_f32 v254, v94, v190
    v_mul_f32 v255, v95, v191
    v_fmaak_f32 v184, v72, v72, 0x409d30fc
    v_fmaak_f32 v185, v73, v73, 0x409d30fc
    v_fmaak_f32 v186, v74, v74, 0x409d30fc
    v_fmaak_f32 v187, v75, v75, 0x409d30fc
    v_fmaak_f32 v188, v76, v76, 0x409d30fc
    v_fmaak_f32 v189, v77, v77, 0x409d30fc
    v_fmaak_f32 v190, v78, v78, 0x409d30fc
    v_fmaak_f32 v191, v79, v79, 0x409d30fc
    v_mul_f32 v184, v72, v184
    v_mul_f32 v185, v73, v185
    v_mul_f32 v186, v74, v186
    v_mul_f32 v187, v75, v187
    v_mul_f32 v188, v76, v188
    v_mul_f32 v189, v77, v189
    v_mul_f32 v190, v78, v190
    v_mul_f32 v191, v79, v191
    s_waitcnt lgkmcnt(0)
    v_readfirstlane_b32 s54, v0
    s_nop 0
    s_add_u32 s54, s54, 0x78787878
    s_andn2_b32 s54, 0x80808080, s54
    s_cbranch_scc0 L_needE17_ok
L_needE17:
    ds_read_b32 v0, v15 offset:4
    s_waitcnt lgkmcnt(0)
    v_readfirstlane_b32 s54, v0
    s_nop 0
    s_add_u32 s54, s54, 0x78787878
    s_andn2_b32 s54, 0x80808080, s54
    s_cbranch_scc1 L_needE17
L_needE17_ok:
    ds_read_b64_tr_b16 v[144:145], v5 offset:46080
    ds_read_b64_tr_b16 v[146:147], v5 offset:47616
    ds_read_b64_tr_b16 v[148:149], v5 offset:46144
    ds_read_b64_tr_b16 v[150:151], v5 offset:47680
    ds_read_b64_tr_b16 v[152:153], v5 offset:46208
    ds_read_b64_tr_b16 v[154:155], v5 offset:47744
    ds_read_b64_tr_b16 v[156:157], v5 offset:61440
    ds_read_b64_tr_b16 v[158:159], v5 offset:62976
    ds_read_b64_tr_b16 v[160:161], v5 offset:61504
    ds_read_b64_tr_b16 v[162:163], v5 offset:63040
    ds_read_b64_tr_b16 v[164:165], v5 offset:61568
    ds_read_b64_tr_b16 v[166:167], v5 offset:63104
    ds_read_b32 v0, v15 offset:0
    s_setprio 1
    v_mfma_f32_32x32x16_bf16 v[80:95], v[120:123], v[96:99], v[192:207]
    v_cvt_pk_bf16_f32 v172, v248, v249
    v_cvt_pk_bf16_f32 v173, v250, v251
    v_rcp_f32 v176, v176
    v_rcp_f32 v177, v177
    v_mfma_f32_32x32x16_bf16 v[80:95], v[124:127], v[100:103], v[80:95]
    v_cvt_pk_bf16_f32 v174, v252, v253
    v_cvt_pk_bf16_f32 v175, v254, v255
    v_rcp_f32 v178, v178
    v_rcp_f32 v179, v179
    v_mfma_f32_32x32x16_bf16 v[80:95], v[128:131], v[104:107], v[80:95]
    v_rcp_f32 v180, v180
    v_rcp_f32 v181, v181
    v_rcp_f32 v182, v182
    v_mfma_f32_32x32x16_bf16 v[80:95], v[132:135], v[108:111], v[80:95]
    v_rcp_f32 v183, v183
    v_exp_f32 v184, v184
    v_exp_f32 v185, v185
    v_mfma_f32_32x32x16_bf16 v[80:95], v[136:139], v[112:115], v[80:95]
    v_exp_f32 v186, v186
    v_exp_f32 v187, v187
    v_exp_f32 v188, v188
    v_mfma_f32_32x32x16_bf16 v[80:95], v[140:143], v[116:119], v[80:95]
    v_exp_f32 v189, v189
    v_exp_f32 v190, v190
    v_exp_f32 v191, v191
    s_setprio 3
    v_add_f32 v184, 1.0, v184
    v_add_f32 v185, 1.0, v185
    v_add_f32 v186, 1.0, v186
    v_add_f32 v187, 1.0, v187
    v_add_f32 v188, 1.0, v188
    v_add_f32 v189, 1.0, v189
    v_add_f32 v190, 1.0, v190
    v_add_f32 v191, 1.0, v191
    v_mul_f32 v64, v64, v176
    v_mul_f32 v65, v65, v177
    v_mul_f32 v66, v66, v178
    v_mul_f32 v67, v67, v179
    v_mul_f32 v68, v68, v180
    v_mul_f32 v69, v69, v181
    v_mul_f32 v70, v70, v182
    v_mul_f32 v71, v71, v183
    v_fmaak_f32 v176, v80, v80, 0x409d30fc
    v_fmaak_f32 v177, v81, v81, 0x409d30fc
    v_fmaak_f32 v178, v82, v82, 0x409d30fc
    v_fmaak_f32 v179, v83, v83, 0x409d30fc
    v_fmaak_f32 v180, v84, v84, 0x409d30fc
    v_fmaak_f32 v181, v85, v85, 0x409d30fc
    v_fmaak_f32 v182, v86, v86, 0x409d30fc
    v_fmaak_f32 v183, v87, v87, 0x409d30fc
    v_mul_f32 v176, v80, v176
    v_mul_f32 v177, v81, v177
    v_mul_f32 v178, v82, v178
    v_mul_f32 v179, v83, v179
    v_mul_f32 v180, v84, v180
    v_mul_f32 v181, v85, v181
    v_mul_f32 v182, v86, v182
    v_mul_f32 v183, v87, v183
    v_add_u32 v4, 49152, v4
    v_add_u32 v5, 49152, v5
    s_waitcnt lgkmcnt(0)
    v_readfirstlane_b32 s54, v0
    s_nop 0
    s_add_u32 s54, s54, 0x77777777
    s_andn2_b32 s54, 0x80808080, s54
    s_cbranch_scc0 L_needE18_ok
L_needE18:
    ds_read_b32 v0, v15 offset:0
    s_waitcnt lgkmcnt(0)
    v_readfirstlane_b32 s54, v0
    s_nop 0
    s_add_u32 s54, s54, 0x77777777
    s_andn2_b32 s54, 0x80808080, s54
    s_cbranch_scc1 L_needE18
L_needE18_ok:
    ds_read_b128 v[192:195], v6 offset:1280
    ds_read_b128 v[196:199], v6 offset:1312
    ds_read_b128 v[200:203], v6 offset:1344
    ds_read_b128 v[204:207], v6 offset:1376
    ds_read_b64_tr_b16 v[120:121], v4 offset:24576
    ds_read_b64_tr_b16 v[122:123], v4 offset:25600
    ds_read_b64_tr_b16 v[124:125], v4 offset:26624
    ds_read_b64_tr_b16 v[126:127], v4 offset:27648
    ds_read_b64_tr_b16 v[128:129], v4 offset:28672
    ds_read_b64_tr_b16 v[130:131], v4 offset:29696
    ds_read_b64_tr_b16 v[132:133], v4 offset:30720
    ds_read_b64_tr_b16 v[134:135], v4 offset:31744
    ds_read_b64_tr_b16 v[136:137], v4 offset:32768
    ds_read_b64_tr_b16 v[138:139], v4 offset:33792
    ds_read_b64_tr_b16 v[140:141], v4 offset:34816
    ds_read_b64_tr_b16 v[142:143], v4 offset:35840
    ds_write_b8 v14, v3
    s_setprio 1
    v_mfma_f32_32x32x16_bf16 v[16:31], v[144:147], v[172:175], v[16:31]
    v_cvt_pk_bf16_f32 v168, v64, v65
    v_cvt_pk_bf16_f32 v169, v66, v67
    v_rcp_f32 v184, v184
    v_rcp_f32 v185, v185
    v_mfma_f32_32x32x16_bf16 v[32:47], v[148:151], v[172:175], v[32:47]
    v_cvt_pk_bf16_f32 v170, v68, v69
    v_cvt_pk_bf16_f32 v171, v70, v71
    v_rcp_f32 v186, v186
    v_rcp_f32 v187, v187
    v_mfma_f32_32x32x16_bf16 v[48:63], v[152:155], v[172:175], v[48:63]
    v_rcp_f32 v188, v188
    v_rcp_f32 v189, v189
    v_rcp_f32 v190, v190
    v_mfma_f32_32x32x16_bf16 v[16:31], v[156:159], v[168:171], v[16:31]
    v_rcp_f32 v191, v191
    v_exp_f32 v176, v176
    v_exp_f32 v177, v177
    v_mfma_f32_32x32x16_bf16 v[32:47], v[160:163], v[168:171], v[32:47]
    v_exp_f32 v178, v178
    v_exp_f32 v179, v179
    v_exp_f32 v180, v180
    v_mfma_f32_32x32x16_bf16 v[48:63], v[164:167], v[168:171], v[48:63]
    v_exp_f32 v181, v181
    v_exp_f32 v182, v182
    v_exp_f32 v183, v183
    s_setprio 3
    v_add_f32 v176, 1.0, v176
    v_add_f32 v177, 1.0, v177
    v_add_f32 v178, 1.0, v178
    v_add_f32 v179, 1.0, v179
    v_add_f32 v180, 1.0, v180
    v_add_f32 v181, 1.0, v181
    v_add_f32 v182, 1.0, v182
    v_add_f32 v183, 1.0, v183
    v_mul_f32 v248, v72, v184
    v_mul_f32 v249, v73, v185
    v_mul_f32 v250, v74, v186
    v_mul_f32 v251, v75, v187
    v_mul_f32 v252, v76, v188
    v_mul_f32 v253, v77, v189
    v_mul_f32 v254, v78, v190
    v_mul_f32 v255, v79, v191
    v_fmaak_f32 v184, v88, v88, 0x409d30fc
    v_fmaak_f32 v185, v89, v89, 0x409d30fc
    v_fmaak_f32 v186, v90, v90, 0x409d30fc
    v_fmaak_f32 v187, v91, v91, 0x409d30fc
    v_fmaak_f32 v188, v92, v92, 0x409d30fc
    v_fmaak_f32 v189, v93, v93, 0x409d30fc
    v_fmaak_f32 v190, v94, v94, 0x409d30fc
    v_fmaak_f32 v191, v95, v95, 0x409d30fc
    v_mul_f32 v184, v88, v184
    v_mul_f32 v185, v89, v185
    v_mul_f32 v186, v90, v186
    v_mul_f32 v187, v91, v187
    v_mul_f32 v188, v92, v188
    v_mul_f32 v189, v93, v189
    v_mul_f32 v190, v94, v190
    v_mul_f32 v191, v95, v191
    v_add_u32 v3, 1, v3
    s_waitcnt lgkmcnt(0)
    ds_read_b64_tr_b16 v[144:145], v5 offset:15360
    ds_read_b64_tr_b16 v[146:147], v5 offset:16896
    ds_read_b64_tr_b16 v[148:149], v5 offset:15424
    ds_read_b64_tr_b16 v[150:151], v5 offset:16960
    ds_read_b64_tr_b16 v[152:153], v5 offset:15488
    ds_read_b64_tr_b16 v[154:155], v5 offset:17024
    ds_read_b64_tr_b16 v[156:157], v5 offset:18432
    ds_read_b64_tr_b16 v[158:159], v5 offset:19968
    ds_read_b64_tr_b16 v[160:161], v5 offset:18496
    ds_read_b64_tr_b16 v[162:163], v5 offset:20032
    ds_read_b64_tr_b16 v[164:165], v5 offset:18560
    ds_read_b64_tr_b16 v[166:167], v5 offset:20096
    s_setprio 1
    v_mfma_f32_32x32x16_bf16 v[64:79], v[120:123], v[96:99], v[192:207]
    v_cvt_pk_bf16_f32 v172, v248, v249
    v_cvt_pk_bf16_f32 v173, v250, v251
    v_rcp_f32 v176, v176
    v_rcp_f32 v177, v177
    v_mfma_f32_32x32x16_bf16 v[64:79], v[124:127], v[100:103], v[64:79]
    v_cvt_pk_bf16_f32 v174, v252, v253
    v_cvt_pk_bf16_f32 v175, v254, v255
    v_rcp_f32 v178, v178
    v_rcp_f32 v179, v179
    v_mfma_f32_32x32x16_bf16 v[64:79], v[128:131], v[104:107], v[64:79]
    v_rcp_f32 v180, v180
    v_rcp_f32 v181, v181
    v_rcp_f32 v182, v182
    v_mfma_f32_32x32x16_bf16 v[64:79], v[132:135], v[108:111], v[64:79]
    v_rcp_f32 v183, v183
    v_exp_f32 v184, v184
    v_exp_f32 v185, v185
    v_mfma_f32_32x32x16_bf16 v[64:79], v[136:139], v[112:115], v[64:79]
    v_exp_f32 v186, v186
    v_exp_f32 v187, v187
    v_exp_f32 v188, v188
    v_mfma_f32_32x32x16_bf16 v[64:79], v[140:143], v[116:119], v[64:79]
    v_exp_f32 v189, v189
    v_exp_f32 v190, v190
    v_exp_f32 v191, v191
    s_setprio 3
    v_add_f32 v184, 1.0, v184
    v_add_f32 v185, 1.0, v185
    v_add_f32 v186, 1.0, v186
    v_add_f32 v187, 1.0, v187
    v_add_f32 v188, 1.0, v188
    v_add_f32 v189, 1.0, v189
    v_add_f32 v190, 1.0, v190
    v_add_f32 v191, 1.0, v191
    v_mul_f32 v80, v80, v176
    v_mul_f32 v81, v81, v177
    v_mul_f32 v82, v82, v178
    v_mul_f32 v83, v83, v179
    v_mul_f32 v84, v84, v180
    v_mul_f32 v85, v85, v181
    v_mul_f32 v86, v86, v182
    v_mul_f32 v87, v87, v183
    v_fmaak_f32 v176, v64, v64, 0x409d30fc
    v_fmaak_f32 v177, v65, v65, 0x409d30fc
    v_fmaak_f32 v178, v66, v66, 0x409d30fc
    v_fmaak_f32 v179, v67, v67, 0x409d30fc
    v_fmaak_f32 v180, v68, v68, 0x409d30fc
    v_fmaak_f32 v181, v69, v69, 0x409d30fc
    v_fmaak_f32 v182, v70, v70, 0x409d30fc
    v_fmaak_f32 v183, v71, v71, 0x409d30fc
    v_mul_f32 v176, v64, v176
    v_mul_f32 v177, v65, v177
    v_mul_f32 v178, v66, v178
    v_mul_f32 v179, v67, v179
    v_mul_f32 v180, v68, v180
    v_mul_f32 v181, v69, v181
    v_mul_f32 v182, v70, v182
    v_mul_f32 v183, v71, v183
    s_waitcnt lgkmcnt(0)
    ds_read_b128 v[192:195], v6 offset:1408
    ds_read_b128 v[196:199], v6 offset:1440
    ds_read_b128 v[200:203], v6 offset:1472
    ds_read_b128 v[204:207], v6 offset:1504
    ds_read_b64_tr_b16 v[120:121], v4 offset:25088
    ds_read_b64_tr_b16 v[122:123], v4 offset:26112
    ds_read_b64_tr_b16 v[124:125], v4 offset:27136
    ds_read_b64_tr_b16 v[126:127], v4 offset:28160
    ds_read_b64_tr_b16 v[128:129], v4 offset:29184
    ds_read_b64_tr_b16 v[130:131], v4 offset:30208
    ds_read_b64_tr_b16 v[132:133], v4 offset:31232
    ds_read_b64_tr_b16 v[134:135], v4 offset:32256
    ds_read_b64_tr_b16 v[136:137], v4 offset:33280
    ds_read_b64_tr_b16 v[138:139], v4 offset:34304
    ds_read_b64_tr_b16 v[140:141], v4 offset:35328
    ds_read_b64_tr_b16 v[142:143], v4 offset:36352
    ds_read_b32 v0, v15 offset:4
    s_setprio 1
    v_mfma_f32_32x32x16_bf16 v[16:31], v[144:147], v[172:175], v[16:31]
    v_cvt_pk_bf16_f32 v168, v80, v81
    v_cvt_pk_bf16_f32 v169, v82, v83
    v_rcp_f32 v184, v184
    v_rcp_f32 v185, v185
    v_mfma_f32_32x32x16_bf16 v[32:47], v[148:151], v[172:175], v[32:47]
    v_cvt_pk_bf16_f32 v170, v84, v85
    v_cvt_pk_bf16_f32 v171, v86, v87
    v_rcp_f32 v186, v186
    v_rcp_f32 v187, v187
    v_mfma_f32_32x32x16_bf16 v[48:63], v[152:155], v[172:175], v[48:63]
    v_rcp_f32 v188, v188
    v_rcp_f32 v189, v189
    v_rcp_f32 v190, v190
    v_mfma_f32_32x32x16_bf16 v[16:31], v[156:159], v[168:171], v[16:31]
    v_rcp_f32 v191, v191
    v_exp_f32 v176, v176
    v_exp_f32 v177, v177
    v_mfma_f32_32x32x16_bf16 v[32:47], v[160:163], v[168:171], v[32:47]
    v_exp_f32 v178, v178
    v_exp_f32 v179, v179
    v_exp_f32 v180, v180
    v_mfma_f32_32x32x16_bf16 v[48:63], v[164:167], v[168:171], v[48:63]
    v_exp_f32 v181, v181
    v_exp_f32 v182, v182
    v_exp_f32 v183, v183
    s_setprio 3
    v_add_f32 v176, 1.0, v176
    v_add_f32 v177, 1.0, v177
    v_add_f32 v178, 1.0, v178
    v_add_f32 v179, 1.0, v179
    v_add_f32 v180, 1.0, v180
    v_add_f32 v181, 1.0, v181
    v_add_f32 v182, 1.0, v182
    v_add_f32 v183, 1.0, v183
    v_mul_f32 v248, v88, v184
    v_mul_f32 v249, v89, v185
    v_mul_f32 v250, v90, v186
    v_mul_f32 v251, v91, v187
    v_mul_f32 v252, v92, v188
    v_mul_f32 v253, v93, v189
    v_mul_f32 v254, v94, v190
    v_mul_f32 v255, v95, v191
    v_fmaak_f32 v184, v72, v72, 0x409d30fc
    v_fmaak_f32 v185, v73, v73, 0x409d30fc
    v_fmaak_f32 v186, v74, v74, 0x409d30fc
    v_fmaak_f32 v187, v75, v75, 0x409d30fc
    v_fmaak_f32 v188, v76, v76, 0x409d30fc
    v_fmaak_f32 v189, v77, v77, 0x409d30fc
    v_fmaak_f32 v190, v78, v78, 0x409d30fc
    v_fmaak_f32 v191, v79, v79, 0x409d30fc
    v_mul_f32 v184, v72, v184
    v_mul_f32 v185, v73, v185
    v_mul_f32 v186, v74, v186
    v_mul_f32 v187, v75, v187
    v_mul_f32 v188, v76, v188
    v_mul_f32 v189, v77, v189
    v_mul_f32 v190, v78, v190
    v_mul_f32 v191, v79, v191
    s_setprio 0
    s_waitcnt lgkmcnt(0)
    v_mfma_f32_32x32x16_bf16 v[80:95], v[120:123], v[96:99], v[192:207]
    v_cvt_pk_bf16_f32 v172, v248, v249
    v_cvt_pk_bf16_f32 v173, v250, v251
    v_rcp_f32 v176, v176
    v_rcp_f32 v177, v177
    v_mfma_f32_32x32x16_bf16 v[80:95], v[124:127], v[100:103], v[80:95]
    v_cvt_pk_bf16_f32 v174, v252, v253
    v_cvt_pk_bf16_f32 v175, v254, v255
    v_rcp_f32 v178, v178
    v_rcp_f32 v179, v179
    v_mfma_f32_32x32x16_bf16 v[80:95], v[128:131], v[104:107], v[80:95]
    v_rcp_f32 v180, v180
    v_rcp_f32 v181, v181
    v_rcp_f32 v182, v182
    v_mfma_f32_32x32x16_bf16 v[80:95], v[132:135], v[108:111], v[80:95]
    v_rcp_f32 v183, v183
    v_exp_f32 v184, v184
    v_exp_f32 v185, v185
    v_mfma_f32_32x32x16_bf16 v[80:95], v[136:139], v[112:115], v[80:95]
    v_exp_f32 v186, v186
    v_exp_f32 v187, v187
    v_exp_f32 v188, v188
    v_mfma_f32_32x32x16_bf16 v[80:95], v[140:143], v[116:119], v[80:95]
    v_exp_f32 v189, v189
    v_exp_f32 v190, v190
    v_exp_f32 v191, v191
    v_readfirstlane_b32 s54, v0
    s_nop 0
    s_add_u32 s54, s54, 0x77777777
    s_andn2_b32 s54, 0x80808080, s54
    s_cbranch_scc0 L_needE21_ok
L_needE21:
    ds_read_b32 v0, v15 offset:4
    s_waitcnt lgkmcnt(0)
    v_readfirstlane_b32 s54, v0
    s_nop 0
    s_add_u32 s54, s54, 0x77777777
    s_andn2_b32 s54, 0x80808080, s54
    s_cbranch_scc1 L_needE21
L_needE21_ok:
    ds_read_b64_tr_b16 v[144:145], v5 offset:21504
    ds_read_b64_tr_b16 v[146:147], v5 offset:23040
    ds_read_b64_tr_b16 v[148:149], v5 offset:21568
    ds_read_b64_tr_b16 v[150:151], v5 offset:23104
    ds_read_b64_tr_b16 v[152:153], v5 offset:21632
    ds_read_b64_tr_b16 v[154:155], v5 offset:23168
    ds_read_b64_tr_b16 v[156:157], v5 offset:36864
    ds_read_b64_tr_b16 v[158:159], v5 offset:38400
    ds_read_b64_tr_b16 v[160:161], v5 offset:36928
    ds_read_b64_tr_b16 v[162:163], v5 offset:38464
    ds_read_b64_tr_b16 v[164:165], v5 offset:36992
    ds_read_b64_tr_b16 v[166:167], v5 offset:38528
    ds_read_b32 v0, v15 offset:0
    v_pk_add_f32 v[184:185], v[184:185], s[4:5]
    v_pk_add_f32 v[186:187], v[186:187], s[4:5]
    v_pk_add_f32 v[188:189], v[188:189], s[4:5]
    v_pk_add_f32 v[190:191], v[190:191], s[4:5]
    v_pk_mul_f32 v[64:65], v[64:65], v[176:177]
    v_pk_mul_f32 v[66:67], v[66:67], v[178:179]
    v_pk_mul_f32 v[68:69], v[68:69], v[180:181]
    v_pk_mul_f32 v[70:71], v[70:71], v[182:183]
    v_pk_fma_f32 v[176:177], v[80:81], v[80:81], s[6:7]
    v_pk_fma_f32 v[178:179], v[82:83], v[82:83], s[6:7]
    v_pk_fma_f32 v[180:181], v[84:85], v[84:85], s[6:7]
    v_pk_fma_f32 v[182:183], v[86:87], v[86:87], s[6:7]
    v_pk_mul_f32 v[176:177], v[80:81], v[176:177]
    v_pk_mul_f32 v[178:179], v[82:83], v[178:179]
    v_pk_mul_f32 v[180:181], v[84:85], v[180:181]
    v_pk_mul_f32 v[182:183], v[86:87], v[182:183]
    s_waitcnt lgkmcnt(0)
    v_mfma_f32_32x32x16_bf16 v[16:31], v[144:147], v[172:175], v[16:31]
    v_cvt_pk_bf16_f32 v168, v64, v65
    v_cvt_pk_bf16_f32 v169, v66, v67
    v_rcp_f32 v184, v184
    v_rcp_f32 v185, v185
    v_mfma_f32_32x32x16_bf16 v[32:47], v[148:151], v[172:175], v[32:47]
    v_cvt_pk_bf16_f32 v170, v68, v69
    v_cvt_pk_bf16_f32 v171, v70, v71
    v_rcp_f32 v186, v186
    v_rcp_f32 v187, v187
    v_mfma_f32_32x32x16_bf16 v[48:63], v[152:155], v[172:175], v[48:63]
    v_rcp_f32 v188, v188
    v_rcp_f32 v189, v189
    v_rcp_f32 v190, v190
    v_mfma_f32_32x32x16_bf16 v[16:31], v[156:159], v[168:171], v[16:31]
    v_rcp_f32 v191, v191
    v_exp_f32 v176, v176
    v_exp_f32 v177, v177
    v_mfma_f32_32x32x16_bf16 v[32:47], v[160:163], v[168:171], v[32:47]
    v_exp_f32 v178, v178
    v_exp_f32 v179, v179
    v_exp_f32 v180, v180
    v_mfma_f32_32x32x16_bf16 v[48:63], v[164:167], v[168:171], v[48:63]
    v_exp_f32 v181, v181
    v_exp_f32 v182, v182
    v_exp_f32 v183, v183
    v_readfirstlane_b32 s54, v0
    s_nop 0
    s_add_u32 s54, s54, 0x76767676
    s_andn2_b32 s54, 0x80808080, s54
    s_cbranch_scc0 L_needE22_ok
L_needE22:
    ds_read_b32 v0, v15 offset:0
    s_waitcnt lgkmcnt(0)
    v_readfirstlane_b32 s54, v0
    s_nop 0
    s_add_u32 s54, s54, 0x76767676
    s_andn2_b32 s54, 0x80808080, s54
    s_cbranch_scc1 L_needE22
L_needE22_ok:
    ds_read_b64_tr_b16 v[120:121], v5 offset:39936
    ds_read_b64_tr_b16 v[122:123], v5 offset:41472
    ds_read_b64_tr_b16 v[124:125], v5 offset:40000
    ds_read_b64_tr_b16 v[126:127], v5 offset:41536
    ds_read_b64_tr_b16 v[128:129], v5 offset:40064
    ds_read_b64_tr_b16 v[130:131], v5 offset:41600
    v_pk_add_f32 v[176:177], v[176:177], s[4:5]
    v_pk_add_f32 v[178:179], v[178:179], s[4:5]
    v_pk_add_f32 v[180:181], v[180:181], s[4:5]
    v_pk_add_f32 v[182:183], v[182:183], s[4:5]
    v_pk_mul_f32 v[72:73], v[72:73], v[184:185]
    v_pk_mul_f32 v[74:75], v[74:75], v[186:187]
    v_pk_mul_f32 v[76:77], v[76:77], v[188:189]
    v_pk_mul_f32 v[78:79], v[78:79], v[190:191]
    v_pk_fma_f32 v[184:185], v[88:89], v[88:89], s[6:7]
    v_pk_fma_f32 v[186:187], v[90:91], v[90:91], s[6:7]
    v_pk_fma_f32 v[188:189], v[92:93], v[92:93], s[6:7]
    v_pk_fma_f32 v[190:191], v[94:95], v[94:95], s[6:7]
    v_pk_mul_f32 v[184:185], v[88:89], v[184:185]
    v_pk_mul_f32 v[186:187], v[90:91], v[186:187]
    v_pk_mul_f32 v[188:189], v[92:93], v[188:189]
    v_pk_mul_f32 v[190:191], v[94:95], v[190:191]
    s_waitcnt lgkmcnt(0)
    v_cvt_pk_bf16_f32 v172, v72, v73
    v_cvt_pk_bf16_f32 v173, v74, v75
    v_cvt_pk_bf16_f32 v174, v76, v77
    v_cvt_pk_bf16_f32 v175, v78, v79
    v_rcp_f32 v176, v176
    v_rcp_f32 v177, v177
    v_mfma_f32_32x32x16_bf16 v[16:31], v[120:123], v[172:175], v[16:31]
    v_rcp_f32 v178, v178
    v_rcp_f32 v179, v179
    v_rcp_f32 v180, v180
    v_mfma_f32_32x32x16_bf16 v[32:47], v[124:127], v[172:175], v[32:47]
    v_rcp_f32 v181, v181
    v_rcp_f32 v182, v182
    v_rcp_f32 v183, v183
    v_mfma_f32_32x32x16_bf16 v[48:63], v[128:131], v[172:175], v[48:63]
    v_exp_f32 v184, v184
    v_exp_f32 v185, v185
    v_exp_f32 v186, v186
    v_exp_f32 v187, v187
    v_exp_f32 v188, v188
    v_exp_f32 v189, v189
    v_exp_f32 v190, v190
    v_exp_f32 v191, v191
    ds_read_b64_tr_b16 v[156:157], v5 offset:43008
    ds_read_b64_tr_b16 v[158:159], v5 offset:44544
    ds_read_b64_tr_b16 v[160:161], v5 offset:43072
    ds_read_b64_tr_b16 v[162:163], v5 offset:44608
    ds_read_b64_tr_b16 v[164:165], v5 offset:43136
    ds_read_b64_tr_b16 v[166:167], v5 offset:44672
    ds_read_b128 v[232:235], v13 offset:2048
    ds_read_b128 v[236:239], v13 offset:2064
    ds_read_b128 v[144:147], v13 offset:2112
    ds_read_b128 v[148:151], v13 offset:2128
    ds_read_b128 v[248:251], v13 offset:2240
    ds_read_b128 v[252:255], v13 offset:2256
    v_pk_add_f32 v[184:185], v[184:185], s[4:5]
    v_pk_add_f32 v[186:187], v[186:187], s[4:5]
    v_pk_add_f32 v[188:189], v[188:189], s[4:5]
    v_pk_add_f32 v[190:191], v[190:191], s[4:5]
    v_pk_mul_f32 v[80:81], v[80:81], v[176:177]
    v_pk_mul_f32 v[82:83], v[82:83], v[178:179]
    v_pk_mul_f32 v[84:85], v[84:85], v[180:181]
    v_pk_mul_f32 v[86:87], v[86:87], v[182:183]
    v_and_b32 v193, 0xffff0000, v208
    v_and_b32 v195, 0xffff0000, v209
    v_and_b32 v197, 0xffff0000, v210
    v_and_b32 v199, 0xffff0000, v211
    v_and_b32 v201, 0xffff0000, v212
    v_and_b32 v203, 0xffff0000, v213
    v_and_b32 v205, 0xffff0000, v214
    v_and_b32 v207, 0xffff0000, v215
    v_and_b32 v97, 0xffff0000, v216
    v_and_b32 v99, 0xffff0000, v217
    v_and_b32 v101, 0xffff0000, v218
    v_and_b32 v103, 0xffff0000, v219
    v_and_b32 v105, 0xffff0000, v220
    v_and_b32 v107, 0xffff0000, v221
    v_and_b32 v109, 0xffff0000, v222
    v_and_b32 v111, 0xffff0000, v223
    s_waitcnt lgkmcnt(0)
    v_cvt_pk_bf16_f32 v168, v80, v81
    v_cvt_pk_bf16_f32 v169, v82, v83
    v_cvt_pk_bf16_f32 v170, v84, v85
    v_cvt_pk_bf16_f32 v171, v86, v87
    v_rcp_f32 v184, v184
    v_rcp_f32 v185, v185
    v_mfma_f32_32x32x16_bf16 v[16:31], v[156:159], v[168:171], v[16:31]
    v_rcp_f32 v186, v186
    v_rcp_f32 v187, v187
    v_rcp_f32 v188, v188
    v_mfma_f32_32x32x16_bf16 v[32:47], v[160:163], v[168:171], v[32:47]
    v_rcp_f32 v189, v189
    v_rcp_f32 v190, v190
    v_rcp_f32 v191, v191
    v_mfma_f32_32x32x16_bf16 v[48:63], v[164:167], v[168:171], v[48:63]
    ds_read_b64_tr_b16 v[132:133], v5 offset:46080
    ds_read_b64_tr_b16 v[134:135], v5 offset:47616
    ds_read_b64_tr_b16 v[136:137], v5 offset:46144
    ds_read_b64_tr_b16 v[138:139], v5 offset:47680
    ds_read_b64_tr_b16 v[140:141], v5 offset:46208
    ds_read_b64_tr_b16 v[142:143], v5 offset:47744
    ds_read_b128 v[64:67], v13 offset:1920
    ds_read_b128 v[68:71], v13 offset:1936
    ds_read_b128 v[72:75], v13 offset:1984
    ds_read_b128 v[76:79], v13 offset:2000
    ds_read_b128 v[176:179], v13 offset:2176
    ds_read_b128 v[180:183], v13 offset:2192
    v_pk_mul_f32 v[88:89], v[88:89], v[184:185]
    v_pk_mul_f32 v[90:91], v[90:91], v[186:187]
    v_pk_mul_f32 v[92:93], v[92:93], v[188:189]
    v_pk_mul_f32 v[94:95], v[94:95], v[190:191]
    v_and_b32 v113, 0xffff0000, v224
    v_and_b32 v115, 0xffff0000, v225
    v_and_b32 v117, 0xffff0000, v226
    v_and_b32 v119, 0xffff0000, v227
    v_and_b32 v241, 0xffff0000, v228
    v_and_b32 v243, 0xffff0000, v229
    v_and_b32 v245, 0xffff0000, v230
    v_and_b32 v247, 0xffff0000, v231
    v_xor_b32 v7, 32, v8
    s_waitcnt lgkmcnt(0)
    v_cvt_pk_bf16_f32 v172, v88, v89
    v_cvt_pk_bf16_f32 v173, v90, v91
    v_cvt_pk_bf16_f32 v174, v92, v93
    v_cvt_pk_bf16_f32 v175, v94, v95
    v_lshlrev_b32 v192, 16, v208
    v_lshlrev_b32 v194, 16, v209
    v_mfma_f32_32x32x16_bf16 v[16:31], v[132:135], v[172:175], v[16:31]
    v_lshlrev_b32 v196, 16, v210
    v_lshlrev_b32 v198, 16, v211
    v_lshlrev_b32 v200, 16, v212
    v_lshlrev_b32 v202, 16, v213
    v_lshlrev_b32 v204, 16, v214
    v_lshlrev_b32 v206, 16, v215
    v_mfma_f32_32x32x16_bf16 v[32:47], v[136:139], v[172:175], v[32:47]
    v_lshlrev_b32 v96, 16, v216
    v_lshlrev_b32 v98, 16, v217
    v_lshlrev_b32 v100, 16, v218
    v_lshlrev_b32 v102, 16, v219
    v_lshlrev_b32 v104, 16, v220
    v_lshlrev_b32 v106, 16, v221
    v_mfma_f32_32x32x16_bf16 v[48:63], v[140:143], v[172:175], v[48:63]
    v_lshlrev_b32 v108, 16, v222
    v_lshlrev_b32 v110, 16, v223
    v_lshlrev_b32 v112, 16, v224
    v_lshlrev_b32 v114, 16, v225
    v_lshlrev_b32 v116, 16, v226
    v_lshlrev_b32 v118, 16, v227
    v_lshlrev_b32 v240, 16, v228
    v_lshlrev_b32 v242, 16, v229
    v_lshlrev_b32 v244, 16, v230
    v_lshlrev_b32 v246, 16, v231
    v_add_u32 v9, s10, v9
    v_pk_fma_f32 v[192:193], v[16:17], v[64:65], v[192:193]
    v_pk_fma_f32 v[194:195], v[18:19], v[66:67], v[194:195]
    v_pk_fma_f32 v[196:197], v[20:21], v[68:69], v[196:197]
    v_pk_fma_f32 v[198:199], v[22:23], v[70:71], v[198:199]
    v_cvt_pk_bf16_f32 v208, v192, v193
    v_cvt_pk_bf16_f32 v209, v194, v195
    v_cvt_pk_bf16_f32 v210, v196, v197
    v_cvt_pk_bf16_f32 v211, v198, v199
    ds_write_b128 v8, v[208:211] offset:0
    v_pk_fma_f32 v[200:201], v[24:25], v[72:73], v[200:201]
    v_pk_fma_f32 v[202:203], v[26:27], v[74:75], v[202:203]
    v_pk_fma_f32 v[204:205], v[28:29], v[76:77], v[204:205]
    v_pk_fma_f32 v[206:207], v[30:31], v[78:79], v[206:207]
    v_cvt_pk_bf16_f32 v212, v200, v201
    v_cvt_pk_bf16_f32 v213, v202, v203
    v_cvt_pk_bf16_f32 v214, v204, v205
    v_cvt_pk_bf16_f32 v215, v206, v207
    ds_write_b128 v7, v[212:215] offset:0
    v_pk_fma_f32 v[96:97], v[32:33], v[232:233], v[96:97]
    v_pk_fma_f32 v[98:99], v[34:35], v[234:235], v[98:99]
    v_pk_fma_f32 v[100:101], v[36:37], v[236:237], v[100:101]
    v_pk_fma_f32 v[102:103], v[38:39], v[238:239], v[102:103]
    v_cvt_pk_bf16_f32 v216, v96, v97
    v_cvt_pk_bf16_f32 v217, v98, v99
    v_cvt_pk_bf16_f32 v218, v100, v101
    v_cvt_pk_bf16_f32 v219, v102, v103
    ds_write_b128 v8, v[216:219] offset:64
    v_pk_fma_f32 v[104:105], v[40:41], v[144:145], v[104:105]
    v_pk_fma_f32 v[106:107], v[42:43], v[146:147], v[106:107]
    v_pk_fma_f32 v[108:109], v[44:45], v[148:149], v[108:109]
    v_pk_fma_f32 v[110:111], v[46:47], v[150:151], v[110:111]
    v_cvt_pk_bf16_f32 v220, v104, v105
    v_cvt_pk_bf16_f32 v221, v106, v107
    v_cvt_pk_bf16_f32 v222, v108, v109
    v_cvt_pk_bf16_f32 v223, v110, v111
    ds_write_b128 v7, v[220:223] offset:64
    v_pk_fma_f32 v[112:113], v[48:49], v[176:177], v[112:113]
    v_pk_fma_f32 v[114:115], v[50:51], v[178:179], v[114:115]
    v_pk_fma_f32 v[116:117], v[52:53], v[180:181], v[116:117]
    v_pk_fma_f32 v[118:119], v[54:55], v[182:183], v[118:119]
    v_cvt_pk_bf16_f32 v224, v112, v113
    v_cvt_pk_bf16_f32 v225, v114, v115
    v_cvt_pk_bf16_f32 v226, v116, v117
    v_cvt_pk_bf16_f32 v227, v118, v119
    ds_write_b128 v8, v[224:227] offset:128
    v_pk_fma_f32 v[240:241], v[56:57], v[248:249], v[240:241]
    v_pk_fma_f32 v[242:243], v[58:59], v[250:251], v[242:243]
    v_pk_fma_f32 v[244:245], v[60:61], v[252:253], v[244:245]
    v_pk_fma_f32 v[246:247], v[62:63], v[254:255], v[246:247]
    v_cvt_pk_bf16_f32 v228, v240, v241
    v_cvt_pk_bf16_f32 v229, v242, v243
    v_cvt_pk_bf16_f32 v230, v244, v245
    v_cvt_pk_bf16_f32 v231, v246, v247
    ds_write_b128 v7, v[228:231] offset:128
    s_add_u32 s54, s57, s59
    ds_read_b128 v[64:67], v9 offset:0
    ds_read_b128 v[68:71], v9 offset:1024
    ds_read_b128 v[72:75], v9 offset:2048
    ds_read_b128 v[76:79], v9 offset:3072
    ds_read_b128 v[80:83], v9 offset:4096
    ds_read_b128 v[84:87], v9 offset:5120
    s_waitcnt lgkmcnt(5)
    buffer_store_dwordx4 v[64:67], v10, s[40:43], s57 offen sc1
    s_waitcnt lgkmcnt(4)
    buffer_store_dwordx4 v[68:71], v11, s[40:43], s57 offen sc1
    s_waitcnt lgkmcnt(3)
    buffer_store_dwordx4 v[72:75], v12, s[40:43], s57 offen sc1
    s_waitcnt lgkmcnt(2)
    buffer_store_dwordx4 v[76:79], v10, s[40:43], s54 offen sc1
    s_waitcnt lgkmcnt(1)
    buffer_store_dwordx4 v[80:83], v11, s[40:43], s54 offen sc1
    s_waitcnt lgkmcnt(0)
    buffer_store_dwordx4 v[84:87], v12, s[40:43], s54 offen sc1
    s_endpgm
L_issueL:
    s_load_dwordx2 s[32:33], s[0:1], 16
    s_load_dwordx2 s[36:37], s[0:1], 32
    s_load_dwordx2 s[40:41], s[0:1], 56
    v_lshlrev_b32 v9, 4, v0
    v_mul_u32_u24 v142, 43, v0
    s_mul_i32 s55, s49, 5
    v_lshrrev_b32 v142, 9, v142
    v_mul_u32_u24 v143, 12, v142
    v_add_u32 v142, s55, v142
    v_sub_u32 v143, v0, v143
    s_lshl_b32 s55, s51, 4
    v_bfe_u32 v144, v142, 2, 2
    s_sub_u32 s55, s55, 2
    v_xor_b32 v143, v143, v144
    v_add_u32 v142, s55, v142
    v_min_u32 v142, 0xe0, v142
    v_add_u32 v144, 32, v142
    v_lshrrev_b32 v144, 8, v144
    v_mul_u32_u24 v142, 0xc0, v142
    v_lshl_add_u32 v142, v143, 4, v142
    v_lshl_add_u32 v1, v144, 29, v142
    s_mul_i32 s52, s50, 602112
    s_bitcmp0_b32 s50, 0
    s_cselect_b32 s62, 1, 0
    s_mov_b32 s59, 43008
    s_cmov_b32 s59, -43008
    s_mov_b32 s54, 430080
    s_cmov_b32 s54, 129024
    s_add_u32 s52, s52, s54
    s_mul_i32 s53, s49, 960
    s_add_u32 s53, s53, 73728
    s_mov_b32 s26, 9633792
    s_mov_b32 s27, 0x20000
    v_mov_b32 v15, 162048
    v_mov_b32 v3, 0
    v_add_u32 v14, s48, v15
    ds_write_b8 v14, v3
    ds_write_b8 v14, v3 offset:4
    v_and_b32 v147, 15, v0
    v_lshrrev_b32 v148, 4, v0
    v_lshrrev_b32 v149, 5, v0
    v_and_b32 v150, 1, v148
    v_bfe_u32 v151, v0, 2, 2
    v_and_b32 v152, 3, v0
    v_bfe_u32 v153, v0, 2, 3
    v_mul_u32_u24 v153, 0x300, v153
    v_lshl_add_u32 v153, v149, 6, v153
    v_lshl_add_u32 v2, v152, 4, v153
    s_mul_i32 s61, s49, 3072
    s_mul_i32 s60, s49, 18432
    s_mov_b32 s34, 73728
    s_mov_b32 s35, 0x20000
    s_mov_b32 s38, 73728
    s_mov_b32 s39, 0x20000
    s_mov_b32 s42, 9633792
    s_mov_b32 s43, 0x20000
    v_mul_u32_u24 v3, 0x5555, v152
    v_and_b32 v153, 2, v152
    v_and_b32 v154, 1, v152
    v_mul_u32_u24 v154, 960, v154
    v_lshlrev_b32 v153, 2, v153
    v_lshl_add_u32 v153, v151, 6, v153
    v_sub_u32 v153, v153, v154
    s_lshl_b32 s54, s49, 4
    s_add_u32 s54, s54, 148416
    v_add_u32 v153, s54, v153
    v_lshlrev_b32 v155, 3, v148
    s_movk_i32 s55, 0xc0
    s_mov_b32 s54, 50397696
    v_bfe_u32 v124, s54, v155, 8
    v_mad_u32_u24 v124, v124, s55, v153
    s_mov_b32 s54, 504892932
    v_bfe_u32 v125, s54, v155, 8
    v_mad_u32_u24 v125, v125, s55, v153
    s_mov_b32 s54, 403571742
    v_bfe_u32 v126, s54, v155, 8
    v_mad_u32_u24 v126, v126, s55, v153
    v_bfe_i32 v153, v0, 3, 1
    v_lshrrev_b32 v130, 16, v153
    v_and_b32 v131, 0xffff0000, v153
    v_xor_b32 v128, 0xffff, v130
    v_xor_b32 v129, 0xffff0000, v131
    s_mov_b32 s55, 104448
    v_lshl_add_u32 v155, v149, 1, v147
    v_bfe_u32 v153, v155, 2, 2
    v_xor_b32 v153, s49, v153
    v_mul_u32_u24 v154, 0xc0, v155
    v_lshl_add_u32 v153, v153, 4, v154
    v_mul_u32_u24 v154, 0xf00, v150
    v_add3_u32 v240, v153, v154, s55
    v_add_u32 v155, 1, v155
    v_bfe_u32 v153, v155, 2, 2
    v_xor_b32 v153, s49, v153
    v_mul_u32_u24 v154, 0xc0, v155
    v_lshl_add_u32 v153, v153, 4, v154
    v_mul_u32_u24 v154, 0xf00, v150
    v_add3_u32 v241, v153, v154, s55
    v_add_u32 v155, 4, v147
    v_bfe_u32 v153, v155, 2, 2
    v_xor_b32 v153, s49, v153
    v_mul_u32_u24 v154, 0xc0, v155
    v_lshl_add_u32 v153, v153, 4, v154
    v_mul_u32_u24 v154, 0xf00, v148
    v_add3_u32 v242, v153, v154, s55
    v_mul_u32_u24 v154, 7680, v149
    v_sub_u32 v154, v242, v154
    v_add_u32 v243, 30720, v154
    s_mul_i32 s55, s48, 7680
    s_add_u32 s55, s55, 81408
    v_add_u32 v155, 2, v147
    v_bfe_u32 v153, v155, 2, 2
    v_xor_b32 v153, v149, v153
    v_mul_u32_u24 v154, 0xc0, v155
    v_lshl_add_u32 v153, v153, 4, v154
    v_mul_u32_u24 v154, 0xf00, v150
    v_add3_u32 v7, v153, v154, s55
    s_lshl_b32 s54, s49, 9
    s_add_u32 s54, s54, 86016
    v_lshl_add_u32 v244, v0, 3, s54
    s_mul_i32 s54, s49, 5632
    s_cmp_eq_u32 s49, 3
    s_cmov_b32 s54, -1536
    v_add_u32 v245, s54, v244
    s_mul_i32 s54, s49, 6144
    s_add_u32 s54, s54, 141312
    v_add_u32 v246, s54, v9
    v_and_b32 v153, 1, v152
    v_lshlrev_b32 v153, 4, v153
    s_movk_i32 s54, 0x3f80
    v_lshlrev_b32_e64 v142, v153, s54
    v_xor_b32 v153, v151, v149
    v_and_b32 v153, 1, v153
    v_xor_b32 v153, 1, v153
    v_bfe_u32 v154, v0, 3, 2
    v_lshrrev_b32 v155, 1, v152
    v_lshl_add_u32 v154, v154, 1, v155
    v_lshlrev_b32 v153, v154, v153
    v_bfe_i32 v248, v153, 0, 1
    v_bfe_i32 v249, v153, 1, 1
    v_bfe_i32 v250, v153, 2, 1
    v_bfe_i32 v251, v153, 3, 1
    v_bfe_i32 v252, v153, 4, 1
    v_bfe_i32 v253, v153, 5, 1
    v_bfe_i32 v254, v153, 6, 1
    v_bfe_i32 v255, v153, 7, 1
    v_and_b32 v248, v248, v142
    v_and_b32 v249, v249, v142
    v_and_b32 v250, v250, v142
    v_and_b32 v251, v251, v142
    v_and_b32 v252, v252, v142
    v_and_b32 v253, v253, v142
    v_and_b32 v254, v254, v142
    v_and_b32 v255, v255, v142
    v_lshl_add_u32 v153, v149, 2, v151
    v_lshlrev_b32 v154, 5, v150
    v_lshl_add_u32 v155, v152, 3, v154
    v_lshl_add_u32 v4, v153, 6, v155
    v_mul_u32_u24 v153, 0xc0, v153
    v_and_b32 v155, 1, v152
    v_lshl_add_u32 v154, v155, 4, v154
    v_lshrrev_b32 v155, 1, v152
    v_lshl_add_u32 v154, v155, 3, v154
    v_add_u32 v5, v153, v154
    v_lshlrev_b32 v153, 4, v149
    v_add_u32 v6, 159744, v153
    v_add_u32 v13, v6, v153
    s_mov_b32 s10, 49152
    s_cmp_eq_u32 s49, 1
    s_cmov_b32 s10, 73728
    s_cmp_eq_u32 s49, 2
    s_cmov_b32 s10, 147456
    v_bfe_u32 v153, v147, 1, 2
    v_xor_b32 v153, v153, v149
    v_and_b32 v154, 31, v0
    v_mul_u32_u24 v154, 0xc0, v154
    v_lshl_add_u32 v153, v153, 4, v154
    v_add_u32 v8, s10, v153
    v_add_u32 v153, 0, v0
    v_mul_u32_u24 v154, 171, v153
    v_bfe_u32 v154, v154, 12, 2
    v_xor_b32 v153, v153, v154
    v_lshlrev_b32 v10, 4, v153
    v_add_u32 v153, 64, v0
    v_mul_u32_u24 v154, 171, v153
    v_bfe_u32 v154, v154, 12, 2
    v_xor_b32 v153, v153, v154
    v_lshlrev_b32 v11, 4, v153
    v_add_u32 v153, 128, v0
    v_mul_u32_u24 v154, 171, v153
    v_bfe_u32 v154, v154, 12, 2
    v_xor_b32 v153, v153, v154
    v_lshlrev_b32 v12, 4, v153
    s_mul_i32 s54, s50, 14
    s_mul_i32 s55, s62, 13
    s_add_u32 s54, s54, s55
    s_mul_i32 s54, s54, 43008
    s_lshl_b32 s55, s48, 1
    s_mul_i32 s55, s55, s59
    s_add_u32 s54, s54, s55
    s_mul_i32 s55, s51, 3072
    s_add_u32 s57, s54, s55
    v_mov_b32 v16, 0
    v_mov_b32 v17, 0
    v_mov_b32 v18, 0
    v_mov_b32 v19, 0
    v_mov_b32 v20, 0
    v_mov_b32 v21, 0
    v_mov_b32 v22, 0
    v_mov_b32 v23, 0
    v_mov_b32 v24, 0
    v_mov_b32 v25, 0
    v_mov_b32 v26, 0
    v_mov_b32 v27, 0
    v_mov_b32 v32, 0
    v_mov_b32 v33, 0
    v_mov_b32 v34, 0
    v_mov_b32 v35, 0
    v_mov_b32 v36, 0
    v_mov_b32 v37, 0
    v_mov_b32 v38, 0
    v_mov_b32 v39, 0
    v_mov_b32 v40, 0
    v_mov_b32 v41, 0
    v_mov_b32 v42, 0
    v_mov_b32 v43, 0
    v_mov_b32 v48, 0
    v_mov_b32 v49, 0
    v_mov_b32 v50, 0
    v_mov_b32 v51, 0
    v_mov_b32 v52, 0
    v_mov_b32 v53, 0
    v_mov_b32 v54, 0
    v_mov_b32 v55, 0
    v_mov_b32 v56, 0
    v_mov_b32 v57, 0
    v_mov_b32 v58, 0
    v_mov_b32 v59, 0
    s_waitcnt lgkmcnt(0)
    s_barrier
    ds_read_b64_tr_b16 v[156:157], v124 offset:0
    ds_read_b64_tr_b16 v[158:159], v124 offset:960
    ds_read_b64_tr_b16 v[160:161], v124 offset:1920
    ds_read_b64_tr_b16 v[162:163], v124 offset:2880
    ds_read_b64_tr_b16 v[164:165], v124 offset:3840
    ds_read_b64_tr_b16 v[166:167], v124 offset:4800
    ds_read_b64_tr_b16 v[168:169], v125 offset:0
    ds_read_b64_tr_b16 v[170:171], v125 offset:960
    ds_read_b64_tr_b16 v[172:173], v126 offset:0
    ds_read_b64_tr_b16 v[174:175], v126 offset:960
    s_bfm_b64 exec, 60, 0
    s_add_u32 m0, s53, 46080
    s_nop 0
    buffer_load_dwordx4 v1, s[24:27], s52 offen nt lds
    s_add_u32 m0, s53, 49920
    s_add_u32 s52, s52, s59
    buffer_load_dwordx4 v1, s[24:27], s52 offen nt lds
    s_add_u32 m0, s53, 53760
    s_add_u32 s52, s52, s59
    buffer_load_dwordx4 v1, s[24:27], s52 offen nt lds
    s_add_u32 m0, s53, 57600
    s_add_u32 s52, s52, s59
    buffer_load_dwordx4 v1, s[24:27], s52 offen nt lds
    s_add_u32 m0, s53, 61440
    s_add_u32 s52, s52, s59
    s_cmp_lt_i32 s52, 0
    s_cmov_b32 s52, 536870912
    buffer_load_dwordx4 v1, s[24:27], s52 offen nt lds
    s_add_u32 m0, s53, 65280
    s_add_u32 s52, s52, s59
    buffer_load_dwordx4 v1, s[24:27], s52 offen nt lds
    s_mov_b64 exec, -1
    s_waitcnt lgkmcnt(8)
    v_and_b32 v64, v156, v128
    v_and_b32 v65, v156, v130
    v_and_b32 v84, v156, v129
    v_and_b32 v85, v156, v131
    v_and_b32 v104, v157, v128
    v_and_b32 v105, v157, v130
    v_and_b32 v66, v158, v128
    v_and_b32 v67, v158, v130
    v_and_b32 v86, v158, v129
    v_and_b32 v87, v158, v131
    v_and_b32 v106, v159, v128
    v_and_b32 v107, v159, v130
    s_waitcnt lgkmcnt(6)
    v_and_b32 v68, v160, v128
    v_and_b32 v69, v160, v130
    v_and_b32 v88, v160, v129
    v_and_b32 v89, v160, v131
    v_and_b32 v108, v161, v128
    v_and_b32 v109, v161, v130
    v_and_b32 v70, v162, v128
    v_and_b32 v71, v162, v130
    v_and_b32 v90, v162, v129
    v_and_b32 v91, v162, v131
    v_and_b32 v110, v163, v128
    v_and_b32 v111, v163, v130
    s_waitcnt lgkmcnt(4)
    v_and_b32 v72, v164, v128
    v_and_b32 v73, v164, v130
    v_and_b32 v92, v164, v129
    v_and_b32 v93, v164, v131
    v_and_b32 v112, v165, v128
    v_and_b32 v113, v165, v130
    v_and_b32 v74, v166, v128
    v_and_b32 v75, v166, v130
    v_and_b32 v94, v166, v129
    v_and_b32 v95, v166, v131
    v_and_b32 v114, v167, v128
    v_and_b32 v115, v167, v130
    s_waitcnt lgkmcnt(2)
    v_and_b32 v76, v168, v128
    v_and_b32 v77, v168, v130
    v_and_b32 v96, v168, v129
    v_and_b32 v97, v168, v131
    v_and_b32 v116, v169, v128
    v_and_b32 v117, v169, v130
    v_and_b32 v78, v170, v128
    v_and_b32 v79, v170, v130
    v_and_b32 v98, v170, v129
    v_and_b32 v99, v170, v131
    v_and_b32 v118, v171, v128
    v_and_b32 v119, v171, v130
    s_waitcnt lgkmcnt(0)
    v_and_b32 v80, v172, v128
    v_and_b32 v81, v172, v130
    v_and_b32 v100, v172, v129
    v_and_b32 v101, v172, v131
    v_and_b32 v120, v173, v128
    v_and_b32 v121, v173, v130
    v_and_b32 v82, v174, v128
    v_and_b32 v83, v174, v130
    v_and_b32 v102, v174, v129
    v_and_b32 v103, v174, v131
    v_and_b32 v122, v175, v128
    v_and_b32 v123, v175, v130
    s_barrier
    s_bfm_b64 exec, 60, 0
    s_mov_b64 exec, -1
    s_add_u32 m0, s61, 0
    s_add_u32 s54, s60, 0
    buffer_load_dwordx4 v2, s[32:35], s54 offen lds
    s_add_u32 m0, s61, 1024
    s_add_u32 s54, s60, 6144
    buffer_load_dwordx4 v2, s[32:35], s54 offen lds
    s_add_u32 m0, s61, 2048
    s_add_u32 s54, s60, 12288
    buffer_load_dwordx4 v2, s[32:35], s54 offen lds
    s_add_u32 m0, s61, 12288
    s_add_u32 s54, s61, 0
    buffer_load_dwordx4 v9, s[36:39], s54 offen offset:0 lds
    buffer_load_dwordx4 v9, s[36:39], s54 offen offset:1024 lds
    buffer_load_dwordx4 v9, s[36:39], s54 offen offset:2048 lds
    s_add_u32 m0, s61, 24576
    s_add_u32 s54, s60, 128
    buffer_load_dwordx4 v2, s[32:35], s54 offen lds
    s_add_u32 m0, s61, 25600
    s_add_u32 s54, s60, 6272
    buffer_load_dwordx4 v2, s[32:35], s54 offen lds
    s_add_u32 m0, s61, 26624
    s_add_u32 s54, s60, 12416
    buffer_load_dwordx4 v2, s[32:35], s54 offen lds
    s_add_u32 m0, s61, 36864
    s_add_u32 s54, s61, 12288
    buffer_load_dwordx4 v9, s[36:39], s54 offen offset:0 lds
    buffer_load_dwordx4 v9, s[36:39], s54 offen offset:1024 lds
    buffer_load_dwordx4 v9, s[36:39], s54 offen offset:2048 lds
    s_add_u32 m0, s61, 49152
    s_add_u32 s54, s60, 256
    buffer_load_dwordx4 v2, s[32:35], s54 offen lds
    s_add_u32 m0, s61, 50176
    s_add_u32 s54, s60, 6400
    buffer_load_dwordx4 v2, s[32:35], s54 offen lds
    s_add_u32 m0, s61, 51200
    s_add_u32 s54, s60, 12544
    buffer_load_dwordx4 v2, s[32:35], s54 offen lds
    s_add_u32 m0, s61, 61440
    s_add_u32 s54, s61, 24576
    buffer_load_dwordx4 v9, s[36:39], s54 offen offset:0 lds
    buffer_load_dwordx4 v9, s[36:39], s54 offen offset:1024 lds
    buffer_load_dwordx4 v9, s[36:39], s54 offen offset:2048 lds
    s_lshl_b32 s61, s49, 12
    s_add_u32 s58, s61, 36864
    s_add_u32 s61, s61, 86016
    s_waitcnt vmcnt(15)
    s_setprio 3
    s_barrier
    ds_read_b128 v[124:127], v240 offset:0
    ds_read_b128 v[128:131], v241 offset:0
    ds_read_b128 v[132:135], v240 offset:7680
    ds_read_b128 v[136:139], v241 offset:7680
    ds_read_b128 v[140:143], v240 offset:15360
    ds_read_b128 v[144:147], v241 offset:15360
    ds_read_b128 v[148:151], v240 offset:23040
    ds_read_b128 v[152:155], v241 offset:23040
    ds_read_b128 v[156:159], v240 offset:30720
    ds_read_b128 v[160:163], v241 offset:30720
    ds_read_b128 v[164:167], v242 offset:0
    ds_read_b128 v[168:171], v242 offset:15360
    ds_read_b128 v[172:175], v243 offset:0
    s_waitcnt lgkmcnt(11)
    ds_read_b128 v[176:179], v240 offset:64
    ds_read_b128 v[180:183], v241 offset:64
    ds_read_b128 v[184:187], v240 offset:7744
    ds_read_b128 v[188:191], v241 offset:7744
    v_smfmac_f32_16x16x64_bf16 v[16:19], v[64:67], v[124:131], v3
    s_waitcnt lgkmcnt(13)
    ds_read_b128 v[192:195], v240 offset:15424
    ds_read_b128 v[196:199], v241 offset:15424
    v_smfmac_f32_16x16x64_bf16 v[16:19], v[68:71], v[132:139], v3
    v_smfmac_f32_16x16x64_bf16 v[20:23], v[64:67], v[132:139], v3
    s_waitcnt lgkmcnt(13)
    ds_read_b128 v[200:203], v240 offset:23104
    ds_read_b128 v[204:207], v241 offset:23104
    v_smfmac_f32_16x16x64_bf16 v[16:19], v[72:75], v[140:147], v3
    v_smfmac_f32_16x16x64_bf16 v[20:23], v[68:71], v[140:147], v3
    v_smfmac_f32_16x16x64_bf16 v[24:27], v[64:67], v[140:147], v3
    s_waitcnt lgkmcnt(13)
    ds_read_b128 v[208:211], v240 offset:30784
    ds_read_b128 v[212:215], v241 offset:30784
    v_smfmac_f32_16x16x64_bf16 v[20:23], v[72:75], v[148:155], v3
    v_smfmac_f32_16x16x64_bf16 v[24:27], v[68:71], v[148:155], v3
    s_waitcnt lgkmcnt(13)
    ds_read_b128 v[216:219], v242 offset:64
    ds_read_b128 v[220:223], v242 offset:15424
    v_smfmac_f32_16x16x64_bf16 v[24:27], v[72:75], v[156:163], v3
    s_waitcnt lgkmcnt(13)
    ds_read_b128 v[224:227], v243 offset:64
    v_smfmac_f32_16x16x64_bf16 v[16:19], v[76:79], v[164:171], v3
    v_smfmac_f32_16x16x64_bf16 v[20:23], v[80:83], v[164:171], v3
    s_waitcnt lgkmcnt(13)
    v_smfmac_f32_16x16x64_bf16 v[24:27], v[76:79], v[168:175], v3
    s_waitcnt lgkmcnt(11)
    ds_read_b128 v[124:127], v240 offset:128
    ds_read_b128 v[128:131], v241 offset:128
    ds_read_b128 v[132:135], v240 offset:7808
    ds_read_b128 v[136:139], v241 offset:7808
    v_smfmac_f32_16x16x64_bf16 v[32:35], v[84:87], v[176:183], v3
    s_waitcnt lgkmcnt(13)
    ds_read_b128 v[140:143], v240 offset:15488
    ds_read_b128 v[144:147], v241 offset:15488
    v_smfmac_f32_16x16x64_bf16 v[32:35], v[88:91], v[184:191], v3
    v_cvt_pk_bf16_f32 v64, v16, v17
    v_smfmac_f32_16x16x64_bf16 v[36:39], v[84:87], v[184:191], v3
    v_cvt_pk_bf16_f32 v65, v18, v19
    s_waitcnt lgkmcnt(13)
    ds_read_b128 v[148:151], v240 offset:23168
    ds_read_b128 v[152:155], v241 offset:23168
    v_smfmac_f32_16x16x64_bf16 v[32:35], v[92:95], v[192:199], v3
    v_cvt_pk_bf16_f32 v66, v20, v21
    v_smfmac_f32_16x16x64_bf16 v[36:39], v[88:91], v[192:199], v3
    v_cvt_pk_bf16_f32 v67, v22, v23
    v_smfmac_f32_16x16x64_bf16 v[40:43], v[84:87], v[192:199], v3
    v_cvt_pk_bf16_f32 v68, v24, v25
    s_waitcnt lgkmcnt(13)
    ds_read_b128 v[156:159], v240 offset:30848
    ds_read_b128 v[160:163], v241 offset:30848
    v_smfmac_f32_16x16x64_bf16 v[36:39], v[92:95], v[200:207], v3
    v_cvt_pk_bf16_f32 v69, v26, v27
    v_smfmac_f32_16x16x64_bf16 v[40:43], v[88:91], v[200:207], v3
    s_waitcnt lgkmcnt(13)
    ds_read_b128 v[164:167], v242 offset:128
    ds_read_b128 v[168:171], v242 offset:15488
    v_smfmac_f32_16x16x64_bf16 v[40:43], v[92:95], v[208:215], v3
    s_waitcnt lgkmcnt(13)
    ds_read_b128 v[172:175], v243 offset:128
    v_smfmac_f32_16x16x64_bf16 v[32:35], v[96:99], v[216:223], v3
    v_smfmac_f32_16x16x64_bf16 v[36:39], v[100:103], v[216:223], v3
    s_waitcnt lgkmcnt(13)
    v_smfmac_f32_16x16x64_bf16 v[40:43], v[96:99], v[220:227], v3
    s_waitcnt lgkmcnt(11)
    v_smfmac_f32_16x16x64_bf16 v[48:51], v[104:107], v[124:131], v3
    s_waitcnt lgkmcnt(9)
    ds_read_b128 v[208:211], v7 offset:0
    ds_write_b64 v244, v[64:65] offset:0
    v_smfmac_f32_16x16x64_bf16 v[48:51], v[108:111], v[132:139], v3
    v_cvt_pk_bf16_f32 v84, v32, v33
    v_smfmac_f32_16x16x64_bf16 v[52:55], v[104:107], v[132:139], v3
    v_cvt_pk_bf16_f32 v85, v34, v35
    s_waitcnt lgkmcnt(9)
    ds_read_b128 v[216:219], v7 offset:64
    ds_write_b64 v244, v[66:67] offset:6144
    v_smfmac_f32_16x16x64_bf16 v[48:51], v[112:115], v[140:147], v3
    v_cvt_pk_bf16_f32 v86, v36, v37
    v_smfmac_f32_16x16x64_bf16 v[52:55], v[108:111], v[140:147], v3
    v_cvt_pk_bf16_f32 v87, v38, v39
    v_smfmac_f32_16x16x64_bf16 v[56:59], v[104:107], v[140:147], v3
    v_cvt_pk_bf16_f32 v88, v40, v41
    s_waitcnt lgkmcnt(9)
    ds_read_b128 v[224:227], v7 offset:128
    ds_write_b64 v244, v[68:69] offset:12288
    v_smfmac_f32_16x16x64_bf16 v[52:55], v[112:115], v[148:155], v3
    v_cvt_pk_bf16_f32 v89, v42, v43
    v_smfmac_f32_16x16x64_bf16 v[56:59], v[108:111], v[148:155], v3
    s_waitcnt lgkmcnt(9)
    v_xor_b32 v7, 32, v7
    ds_read_b128 v[212:215], v7 offset:0
    ds_write_b64 v244, v[84:85] offset:2048
    v_smfmac_f32_16x16x64_bf16 v[56:59], v[112:115], v[156:163], v3
    s_waitcnt lgkmcnt(9)
    ds_read_b128 v[220:223], v7 offset:64
    ds_write_b64 v244, v[86:87] offset:8192
    v_smfmac_f32_16x16x64_bf16 v[48:51], v[116:119], v[164:171], v3
    v_smfmac_f32_16x16x64_bf16 v[52:55], v[120:123], v[164:171], v3
    s_waitcnt lgkmcnt(10)
    ds_read_b128 v[228:231], v7 offset:128
    ds_write_b64 v244, v[88:89] offset:14336
    v_smfmac_f32_16x16x64_bf16 v[56:59], v[116:119], v[168:175], v3
    s_nop 2
    v_cvt_pk_bf16_f32 v104, v48, v49
    v_cvt_pk_bf16_f32 v105, v50, v51
    ds_write_b64 v244, v[104:105] offset:4096
    v_cvt_pk_bf16_f32 v106, v52, v53
    v_cvt_pk_bf16_f32 v107, v54, v55
    ds_write_b64 v244, v[106:107] offset:10240
    v_cvt_pk_bf16_f32 v108, v56, v57
    v_cvt_pk_bf16_f32 v109, v58, v59
    ds_write_b64 v244, v[108:109] offset:16384
    s_waitcnt vmcnt(0)
    v_mov_b32 v234, 5
    ds_write_b8 v14, v234
    v_mov_b32 v80, 0xbf80bf80
    v_mov_b32 v81, 0xbf80bf80
    v_mov_b32 v82, 0xbf80bf80
    v_mov_b32 v83, 0xbf80bf80
    v_mov_b32 v233, 0x3727c5ac
    v_mov_b32 v3, 6
    s_setprio 3
L_pollEx:
    ds_read_b32 v236, v15 offset:4
    s_waitcnt lgkmcnt(0)
    v_readfirstlane_b32 s54, v236
    s_nop 0
    s_add_u32 s54, s54, 0x7b7b7b7b
    s_andn2_b32 s54, 0x80808080, s54
    s_cbranch_scc1 L_pollEx
    s_cmp_eq_u32 s49, 3
    s_cbranch_scc1 L_helper
    ds_read_b64 v[96:97], v245 offset:0
    ds_read_b64 v[98:99], v245 offset:512
    ds_read_b64 v[100:101], v245 offset:1024
    ds_read_b64 v[102:103], v245 offset:1536
    ds_read_b64 v[104:105], v245 offset:2048
    ds_read_b64 v[106:107], v245 offset:2560
    ds_read_b64 v[108:109], v245 offset:3072
    ds_read_b64 v[110:111], v245 offset:3584
    ds_read_b64 v[112:113], v245 offset:4096
    ds_read_b64 v[114:115], v245 offset:4608
    ds_read_b64 v[116:117], v245 offset:5120
    ds_read_b64 v[118:119], v245 offset:5632
    s_waitcnt lgkmcnt(10)
    v_mfma_f32_32x32x16_bf16 v[16:31], v[248:251], v[96:99], 0
    s_waitcnt lgkmcnt(8)
    v_mfma_f32_32x32x16_bf16 v[16:31], v[252:255], v[100:103], v[16:31]
    s_waitcnt lgkmcnt(4)
    ds_read_b128 v[192:195], v6 offset:384
    ds_read_b128 v[196:199], v6 offset:416
    ds_read_b128 v[200:203], v6 offset:448
    ds_read_b128 v[204:207], v6 offset:480
    v_mfma_f32_32x32x16_bf16 v[32:47], v[248:251], v[104:107], 0
    ds_read_b64_tr_b16 v[120:121], v4 offset:25088
    ds_read_b64_tr_b16 v[122:123], v4 offset:26112
    ds_read_b64_tr_b16 v[124:125], v4 offset:27136
    ds_read_b64_tr_b16 v[126:127], v4 offset:28160
    v_mfma_f32_32x32x16_bf16 v[32:47], v[252:255], v[108:111], v[32:47]
    s_waitcnt lgkmcnt(8)
    ds_write_b8 v14, v3
    ds_read_b64_tr_b16 v[128:129], v4 offset:29184
    ds_read_b64_tr_b16 v[130:131], v4 offset:30208
    ds_read_b64_tr_b16 v[132:133], v4 offset:31232
    v_mfma_f32_32x32x16_bf16 v[48:63], v[248:251], v[112:115], 0
    ds_read_b64_tr_b16 v[134:135], v4 offset:32256
    ds_read_b64_tr_b16 v[136:137], v4 offset:33280
    ds_read_b64_tr_b16 v[138:139], v4 offset:34304
    ds_read_b64_tr_b16 v[140:141], v4 offset:35328
    ds_read_b64_tr_b16 v[142:143], v4 offset:36352
    v_mfma_f32_32x32x16_bf16 v[48:63], v[252:255], v[116:119], v[48:63]
    v_mul_f32 v238, v16, v16
    v_mul_f32 v239, v17, v17
    v_fmac_f32 v238, v18, v18
    v_fmac_f32 v239, v19, v19
    v_fmac_f32 v238, v20, v20
    v_fmac_f32 v239, v21, v21
    v_mfma_f32_32x32x16_bf16 v[176:191], v[80:83], v[96:99], 0
    v_fmac_f32 v238, v22, v22
    v_fmac_f32 v239, v23, v23
    v_fmac_f32 v238, v24, v24
    v_fmac_f32 v239, v25, v25
    v_fmac_f32 v238, v26, v26
    v_fmac_f32 v239, v27, v27
    v_mfma_f32_32x32x16_bf16 v[176:191], v[80:83], v[100:103], v[176:191]
    v_fmac_f32 v238, v28, v28
    v_fmac_f32 v239, v29, v29
    v_fmac_f32 v238, v30, v30
    v_fmac_f32 v239, v31, v31
    v_fmac_f32 v238, v32, v32
    v_fmac_f32 v239, v33, v33
    v_mfma_f32_32x32x16_bf16 v[176:191], v[80:83], v[104:107], v[176:191]
    v_fmac_f32 v238, v34, v34
    v_fmac_f32 v239, v35, v35
    v_fmac_f32 v238, v36, v36
    v_fmac_f32 v239, v37, v37
    v_fmac_f32 v238, v38, v38
    v_fmac_f32 v239, v39, v39
    v_mfma_f32_32x32x16_bf16 v[176:191], v[80:83], v[108:111], v[176:191]
    v_fmac_f32 v238, v40, v40
    v_fmac_f32 v239, v41, v41
    v_fmac_f32 v238, v42, v42
    v_fmac_f32 v239, v43, v43
    v_fmac_f32 v238, v44, v44
    v_fmac_f32 v239, v45, v45
    v_mfma_f32_32x32x16_bf16 v[176:191], v[80:83], v[112:115], v[176:191]
    v_fmac_f32 v238, v46, v46
    v_fmac_f32 v239, v47, v47
    v_fmac_f32 v238, v48, v48
    v_fmac_f32 v239, v49, v49
    v_fmac_f32 v238, v50, v50
    v_fmac_f32 v239, v51, v51
    v_mfma_f32_32x32x16_bf16 v[176:191], v[80:83], v[116:119], v[176:191]
    v_fmac_f32 v238, v52, v52
    v_fmac_f32 v239, v53, v53
    v_fmac_f32 v238, v54, v54
    v_fmac_f32 v239, v55, v55
    v_fmac_f32 v238, v56, v56
    v_fmac_f32 v239, v57, v57
    v_fmac_f32 v238, v58, v58
    v_fmac_f32 v239, v59, v59
    v_fmac_f32 v238, v60, v60
    v_fmac_f32 v239, v61, v61
    v_fmac_f32 v238, v62, v62
    v_fmac_f32 v239, v63, v63
    v_add_f32 v238, v238, v239
    v_mov_b32 v239, v238
    v_mul_f32 v176, 0x3c2aaaab, v176
    s_nop 0
    v_permlane32_swap_b32 v238, v239
    v_add_f32 v238, v238, v239
    v_fmamk_f32 v238, v238, 0x3c2aaaab, v233
    v_fma_f32 v238, -v176, v176, v238
    v_max_f32 v238, v233, v238
    v_rsq_f32 v233, v238
    s_waitcnt lgkmcnt(0)
    v_mul_f32 v232, 0xbeeff558, v233
    v_mul_f32 v233, 0xbeeff558, v233
    v_mul_f32 v234, v176, v232
    v_mul_f32 v235, v176, v232
    v_pk_fma_f32 v[16:17], v[16:17], v[232:233], v[234:235]
    v_pk_fma_f32 v[18:19], v[18:19], v[232:233], v[234:235]
    v_pk_fma_f32 v[20:21], v[20:21], v[232:233], v[234:235]
    v_pk_fma_f32 v[22:23], v[22:23], v[232:233], v[234:235]
    v_pk_fma_f32 v[24:25], v[24:25], v[232:233], v[234:235]
    v_pk_fma_f32 v[26:27], v[26:27], v[232:233], v[234:235]
    v_pk_fma_f32 v[28:29], v[28:29], v[232:233], v[234:235]
    v_pk_fma_f32 v[30:31], v[30:31], v[232:233], v[234:235]
    v_pk_fma_f32 v[32:33], v[32:33], v[232:233], v[234:235]
    v_pk_fma_f32 v[34:35], v[34:35], v[232:233], v[234:235]
    v_pk_fma_f32 v[36:37], v[36:37], v[232:233], v[234:235]
    v_pk_fma_f32 v[38:39], v[38:39], v[232:233], v[234:235]
    v_pk_fma_f32 v[40:41], v[40:41], v[232:233], v[234:235]
    v_pk_fma_f32 v[42:43], v[42:43], v[232:233], v[234:235]
    v_pk_fma_f32 v[44:45], v[44:45], v[232:233], v[234:235]
    v_pk_fma_f32 v[46:47], v[46:47], v[232:233], v[234:235]
    v_pk_fma_f32 v[48:49], v[48:49], v[232:233], v[234:235]
    v_pk_fma_f32 v[50:51], v[50:51], v[232:233], v[234:235]
    v_pk_fma_f32 v[52:53], v[52:53], v[232:233], v[234:235]
    v_pk_fma_f32 v[54:55], v[54:55], v[232:233], v[234:235]
    v_pk_fma_f32 v[56:57], v[56:57], v[232:233], v[234:235]
    v_pk_fma_f32 v[58:59], v[58:59], v[232:233], v[234:235]
    v_pk_fma_f32 v[60:61], v[60:61], v[232:233], v[234:235]
    v_pk_fma_f32 v[62:63], v[62:63], v[232:233], v[234:235]
    v_cvt_pk_bf16_f32 v96, v16, v17
    v_cvt_pk_bf16_f32 v97, v18, v19
    v_cvt_pk_bf16_f32 v98, v20, v21
    v_cvt_pk_bf16_f32 v99, v22, v23
    v_cvt_pk_bf16_f32 v100, v24, v25
    v_cvt_pk_bf16_f32 v101, v26, v27
    v_mfma_f32_32x32x16_bf16 v[80:95], v[120:123], v[96:99], v[192:207]
    v_cvt_pk_bf16_f32 v102, v28, v29
    v_cvt_pk_bf16_f32 v103, v30, v31
    v_cvt_pk_bf16_f32 v104, v32, v33
    v_cvt_pk_bf16_f32 v105, v34, v35
    v_mfma_f32_32x32x16_bf16 v[80:95], v[124:127], v[100:103], v[80:95]
    v_cvt_pk_bf16_f32 v106, v36, v37
    v_cvt_pk_bf16_f32 v107, v38, v39
    v_cvt_pk_bf16_f32 v108, v40, v41
    v_cvt_pk_bf16_f32 v109, v42, v43
    v_mfma_f32_32x32x16_bf16 v[80:95], v[128:131], v[104:107], v[80:95]
    v_cvt_pk_bf16_f32 v110, v44, v45
    v_cvt_pk_bf16_f32 v111, v46, v47
    v_cvt_pk_bf16_f32 v112, v48, v49
    v_cvt_pk_bf16_f32 v113, v50, v51
    v_mfma_f32_32x32x16_bf16 v[80:95], v[132:135], v[108:111], v[80:95]
    v_cvt_pk_bf16_f32 v114, v52, v53
    v_cvt_pk_bf16_f32 v115, v54, v55
    v_cvt_pk_bf16_f32 v116, v56, v57
    v_cvt_pk_bf16_f32 v117, v58, v59
    v_mfma_f32_32x32x16_bf16 v[80:95], v[136:139], v[112:115], v[80:95]
    v_cvt_pk_bf16_f32 v118, v60, v61
    v_cvt_pk_bf16_f32 v119, v62, v63
    v_mov_b32 v1, 1
    ds_read_b128 v[16:19], v13 offset:1536
    v_mfma_f32_32x32x16_bf16 v[80:95], v[140:143], v[116:119], v[80:95]
    ds_read_b128 v[20:23], v13 offset:1552
    ds_read_b128 v[24:27], v13 offset:1600
    ds_read_b128 v[28:31], v13 offset:1616
    ds_read_b128 v[32:35], v13 offset:1664
    ds_read_b128 v[36:39], v13 offset:1680
    ds_read_b128 v[40:43], v13 offset:1728
    ds_read_b128 v[44:47], v13 offset:1744
    ds_read_b128 v[48:51], v13 offset:1792
    ds_read_b128 v[52:55], v13 offset:1808
    ds_read_b128 v[56:59], v13 offset:1856
    ds_read_b128 v[60:63], v13 offset:1872
    s_setprio 0
    v_mov_b32 v3, 7
    v_fmaak_f32 v176, v80, v80, 0x409d30fc
    v_fmaak_f32 v177, v81, v81, 0x409d30fc
    v_fmaak_f32 v178, v82, v82, 0x409d30fc
    v_fmaak_f32 v179, v83, v83, 0x409d30fc
    v_fmaak_f32 v180, v84, v84, 0x409d30fc
    v_fmaak_f32 v181, v85, v85, 0x409d30fc
    v_fmaak_f32 v182, v86, v86, 0x409d30fc
    v_fmaak_f32 v183, v87, v87, 0x409d30fc
    v_mul_f32 v176, v80, v176
    v_mul_f32 v177, v81, v177
    v_mul_f32 v178, v82, v178
    v_mul_f32 v179, v83, v179
    v_mul_f32 v180, v84, v180
    v_mul_f32 v181, v85, v181
    v_mul_f32 v182, v86, v182
    v_mul_f32 v183, v87, v183
    s_setprio 2
    s_waitcnt lgkmcnt(0)
    v_exp_f32 v176, v176
    v_exp_f32 v177, v177
    v_exp_f32 v178, v178
    v_exp_f32 v179, v179
    v_exp_f32 v180, v180
    v_exp_f32 v181, v181
    v_exp_f32 v182, v182
    v_exp_f32 v183, v183
    s_setprio 0
    ds_read_b128 v[192:195], v6 offset:512
    ds_read_b128 v[196:199], v6 offset:544
    ds_read_b128 v[200:203], v6 offset:576
    ds_read_b128 v[204:207], v6 offset:608
    ds_read_b64_tr_b16 v[120:121], v4 offset:49152
    ds_read_b64_tr_b16 v[122:123], v4 offset:50176
    ds_read_b64_tr_b16 v[124:125], v4 offset:51200
    ds_read_b64_tr_b16 v[126:127], v4 offset:52224
    ds_read_b64_tr_b16 v[128:129], v4 offset:53248
    ds_read_b64_tr_b16 v[130:131], v4 offset:54272
    ds_read_b64_tr_b16 v[132:133], v4 offset:55296
    ds_read_b64_tr_b16 v[134:135], v4 offset:56320
    ds_read_b64_tr_b16 v[136:137], v4 offset:57344
    ds_read_b64_tr_b16 v[138:139], v4 offset:58368
    ds_read_b64_tr_b16 v[140:141], v4 offset:59392
    ds_read_b64_tr_b16 v[142:143], v4 offset:60416
    ds_read_b32 v0, v15 offset:4
    v_add_f32 v176, 1.0, v176
    v_add_f32 v177, 1.0, v177
    v_add_f32 v178, 1.0, v178
    v_add_f32 v179, 1.0, v179
    v_add_f32 v180, 1.0, v180
    v_add_f32 v181, 1.0, v181
    v_add_f32 v182, 1.0, v182
    v_add_f32 v183, 1.0, v183
    v_fmaak_f32 v184, v88, v88, 0x409d30fc
    v_fmaak_f32 v185, v89, v89, 0x409d30fc
    v_fmaak_f32 v186, v90, v90, 0x409d30fc
    v_fmaak_f32 v187, v91, v91, 0x409d30fc
    v_fmaak_f32 v188, v92, v92, 0x409d30fc
    v_fmaak_f32 v189, v93, v93, 0x409d30fc
    v_fmaak_f32 v190, v94, v94, 0x409d30fc
    v_fmaak_f32 v191, v95, v95, 0x409d30fc
    v_mul_f32 v184, v88, v184
    v_mul_f32 v185, v89, v185
    v_mul_f32 v186, v90, v186
    v_mul_f32 v187, v91, v187
    v_mul_f32 v188, v92, v188
    v_mul_f32 v189, v93, v189
    v_mul_f32 v190, v94, v190
    v_mul_f32 v191, v95, v191
    s_setprio 2
    s_waitcnt lgkmcnt(0)
    v_mfma_f32_32x32x16_bf16 v[64:79], v[120:123], v[96:99], v[192:207]
    v_rcp_f32 v176, v176
    v_rcp_f32 v177, v177
    v_rcp_f32 v178, v178
    v_mfma_f32_32x32x16_bf16 v[64:79], v[124:127], v[100:103], v[64:79]
    v_rcp_f32 v179, v179
    v_rcp_f32 v180, v180
    v_rcp_f32 v181, v181
    v_mfma_f32_32x32x16_bf16 v[64:79], v[128:131], v[104:107], v[64:79]
    v_rcp_f32 v182, v182
    v_rcp_f32 v183, v183
    v_exp_f32 v184, v184
    v_mfma_f32_32x32x16_bf16 v[64:79], v[132:135], v[108:111], v[64:79]
    v_exp_f32 v185, v185
    v_exp_f32 v186, v186
    v_exp_f32 v187, v187
    v_mfma_f32_32x32x16_bf16 v[64:79], v[136:139], v[112:115], v[64:79]
    v_exp_f32 v188, v188
    v_exp_f32 v189, v189
    v_exp_f32 v190, v190
    v_mfma_f32_32x32x16_bf16 v[64:79], v[140:143], v[116:119], v[64:79]
    v_exp_f32 v191, v191
    v_readfirstlane_b32 s54, v0
    s_setprio 0
    s_add_u32 s54, s54, 0x7a7a7a7a
    s_andn2_b32 s54, 0x80808080, s54
    s_cbranch_scc0 L_needL7_ok
L_needL7:
    ds_read_b32 v0, v15 offset:4
    s_waitcnt lgkmcnt(0)
    v_readfirstlane_b32 s54, v0
    s_nop 0
    s_add_u32 s54, s54, 0x7a7a7a7a
    s_andn2_b32 s54, 0x80808080, s54
    s_cbranch_scc1 L_needL7
L_needL7_ok:
    ds_read_b64_tr_b16 v[156:157], v5 offset:43008
    ds_read_b64_tr_b16 v[158:159], v5 offset:44544
    ds_read_b64_tr_b16 v[160:161], v5 offset:43072
    ds_read_b64_tr_b16 v[162:163], v5 offset:44608
    ds_read_b64_tr_b16 v[164:165], v5 offset:43136
    ds_read_b64_tr_b16 v[166:167], v5 offset:44672
    s_cmp_eq_u32 s49, 0
    s_cbranch_scc1 L_nohand
    ds_write_b128 v246, v[96:99] offset:0
    ds_write_b128 v246, v[100:103] offset:1024
    ds_write_b128 v246, v[104:107] offset:2048
    ds_write_b128 v246, v[108:111] offset:3072
    ds_write_b128 v246, v[112:115] offset:4096
    ds_write_b128 v246, v[116:119] offset:5120
    ds_write_b8 v14, v1 offset:4
L_nohand:
    s_mov_b32 m0, s61
    s_add_u32 s61, s61, 24576
    buffer_load_dwordx4 v9, s[36:39], s58 offen offset:0 lds
    buffer_load_dwordx4 v9, s[36:39], s58 offen offset:1024 lds
    v_add_f32 v184, 1.0, v184
    v_add_f32 v185, 1.0, v185
    v_add_f32 v186, 1.0, v186
    v_add_f32 v187, 1.0, v187
    v_add_f32 v188, 1.0, v188
    v_add_f32 v189, 1.0, v189
    v_add_f32 v190, 1.0, v190
    v_add_f32 v191, 1.0, v191
    v_mul_f32 v80, v80, v176
    v_mul_f32 v81, v81, v177
    v_mul_f32 v82, v82, v178
    v_mul_f32 v83, v83, v179
    v_mul_f32 v84, v84, v180
    v_mul_f32 v85, v85, v181
    v_mul_f32 v86, v86, v182
    v_mul_f32 v87, v87, v183
    v_fmaak_f32 v176, v64, v64, 0x409d30fc
    v_fmaak_f32 v177, v65, v65, 0x409d30fc
    v_fmaak_f32 v178, v66, v66, 0x409d30fc
    v_fmaak_f32 v179, v67, v67, 0x409d30fc
    v_fmaak_f32 v180, v68, v68, 0x409d30fc
    v_fmaak_f32 v181, v69, v69, 0x409d30fc
    v_fmaak_f32 v182, v70, v70, 0x409d30fc
    v_fmaak_f32 v183, v71, v71, 0x409d30fc
    v_mul_f32 v176, v64, v176
    v_mul_f32 v177, v65, v177
    v_mul_f32 v178, v66, v178
    v_mul_f32 v179, v67, v179
    v_mul_f32 v180, v68, v180
    v_mul_f32 v181, v69, v181
    v_mul_f32 v182, v70, v182
    v_mul_f32 v183, v71, v183
    s_setprio 2
    s_waitcnt lgkmcnt(0)
    v_cvt_pk_bf16_f32 v168, v80, v81
    v_cvt_pk_bf16_f32 v169, v82, v83
    v_cvt_pk_bf16_f32 v170, v84, v85
    v_cvt_pk_bf16_f32 v171, v86, v87
    v_rcp_f32 v184, v184
    v_rcp_f32 v185, v185
    v_mfma_f32_32x32x16_bf16 v[16:31], v[156:159], v[168:171], v[16:31]
    v_rcp_f32 v186, v186
    v_rcp_f32 v187, v187
    v_rcp_f32 v188, v188
    v_mfma_f32_32x32x16_bf16 v[32:47], v[160:163], v[168:171], v[32:47]
    v_rcp_f32 v189, v189
    v_rcp_f32 v190, v190
    v_rcp_f32 v191, v191
    v_mfma_f32_32x32x16_bf16 v[48:63], v[164:167], v[168:171], v[48:63]
    v_exp_f32 v176, v176
    v_exp_f32 v177, v177
    v_exp_f32 v178, v178
    v_exp_f32 v179, v179
    v_exp_f32 v180, v180
    v_exp_f32 v181, v181
    v_exp_f32 v182, v182
    v_exp_f32 v183, v183
    s_setprio 0
    ds_read_b128 v[192:195], v6 offset:640
    ds_read_b128 v[196:199], v6 offset:672
    ds_read_b128 v[200:203], v6 offset:704
    ds_read_b128 v[204:207], v6 offset:736
    ds_read_b64_tr_b16 v[120:121], v4 offset:49664
    ds_read_b64_tr_b16 v[122:123], v4 offset:50688
    ds_read_b64_tr_b16 v[124:125], v4 offset:51712
    ds_read_b64_tr_b16 v[126:127], v4 offset:52736
    ds_read_b64_tr_b16 v[128:129], v4 offset:53760
    ds_read_b64_tr_b16 v[130:131], v4 offset:54784
    ds_read_b64_tr_b16 v[132:133], v4 offset:55808
    ds_read_b64_tr_b16 v[134:135], v4 offset:56832
    ds_read_b64_tr_b16 v[136:137], v4 offset:57856
    ds_read_b64_tr_b16 v[138:139], v4 offset:58880
    ds_read_b64_tr_b16 v[140:141], v4 offset:59904
    ds_read_b64_tr_b16 v[142:143], v4 offset:60928
    buffer_load_dwordx4 v9, s[36:39], s58 offen offset:2048 lds
    v_add_f32 v176, 1.0, v176
    v_add_f32 v177, 1.0, v177
    v_add_f32 v178, 1.0, v178
    v_add_f32 v179, 1.0, v179
    v_add_f32 v180, 1.0, v180
    v_add_f32 v181, 1.0, v181
    v_add_f32 v182, 1.0, v182
    v_add_f32 v183, 1.0, v183
    v_mul_f32 v248, v88, v184
    v_mul_f32 v249, v89, v185
    v_mul_f32 v250, v90, v186
    v_mul_f32 v251, v91, v187
    v_mul_f32 v252, v92, v188
    v_mul_f32 v253, v93, v189
    v_mul_f32 v254, v94, v190
    v_mul_f32 v255, v95, v191
    v_fmaak_f32 v184, v72, v72, 0x409d30fc
    v_fmaak_f32 v185, v73, v73, 0x409d30fc
    v_fmaak_f32 v186, v74, v74, 0x409d30fc
    v_fmaak_f32 v187, v75, v75, 0x409d30fc
    v_fmaak_f32 v188, v76, v76, 0x409d30fc
    v_fmaak_f32 v189, v77, v77, 0x409d30fc
    v_fmaak_f32 v190, v78, v78, 0x409d30fc
    v_fmaak_f32 v191, v79, v79, 0x409d30fc
    v_mul_f32 v184, v72, v184
    v_mul_f32 v185, v73, v185
    v_mul_f32 v186, v74, v186
    v_mul_f32 v187, v75, v187
    v_mul_f32 v188, v76, v188
    v_mul_f32 v189, v77, v189
    v_mul_f32 v190, v78, v190
    v_mul_f32 v191, v79, v191
    s_setprio 2
    s_waitcnt lgkmcnt(0)
    v_mfma_f32_32x32x16_bf16 v[80:95], v[120:123], v[96:99], v[192:207]
    v_cvt_pk_bf16_f32 v172, v248, v249
    v_cvt_pk_bf16_f32 v173, v250, v251
    v_rcp_f32 v176, v176
    v_rcp_f32 v177, v177
    v_mfma_f32_32x32x16_bf16 v[80:95], v[124:127], v[100:103], v[80:95]
    v_cvt_pk_bf16_f32 v174, v252, v253
    v_cvt_pk_bf16_f32 v175, v254, v255
    v_rcp_f32 v178, v178
    v_rcp_f32 v179, v179
    v_mfma_f32_32x32x16_bf16 v[80:95], v[128:131], v[104:107], v[80:95]
    v_rcp_f32 v180, v180
    v_rcp_f32 v181, v181
    v_rcp_f32 v182, v182
    v_mfma_f32_32x32x16_bf16 v[80:95], v[132:135], v[108:111], v[80:95]
    v_rcp_f32 v183, v183
    v_exp_f32 v184, v184
    v_exp_f32 v185, v185
    v_mfma_f32_32x32x16_bf16 v[80:95], v[136:139], v[112:115], v[80:95]
    v_exp_f32 v186, v186
    v_exp_f32 v187, v187
    v_exp_f32 v188, v188
    v_mfma_f32_32x32x16_bf16 v[80:95], v[140:143], v[116:119], v[80:95]
    v_exp_f32 v189, v189
    v_exp_f32 v190, v190
    v_exp_f32 v191, v191
    s_setprio 0
    ds_read_b64_tr_b16 v[144:145], v5 offset:46080
    ds_read_b64_tr_b16 v[146:147], v5 offset:47616
    ds_read_b64_tr_b16 v[148:149], v5 offset:46144
    ds_read_b64_tr_b16 v[150:151], v5 offset:47680
    ds_read_b64_tr_b16 v[152:153], v5 offset:46208
    ds_read_b64_tr_b16 v[154:155], v5 offset:47744
    ds_read_b64_tr_b16 v[156:157], v5 offset:61440
    ds_read_b64_tr_b16 v[158:159], v5 offset:62976
    ds_read_b64_tr_b16 v[160:161], v5 offset:61504
    ds_read_b64_tr_b16 v[162:163], v5 offset:63040
    ds_read_b64_tr_b16 v[164:165], v5 offset:61568
    ds_read_b64_tr_b16 v[166:167], v5 offset:63104
    buffer_load_dwordx4 v9, s[36:39], s58 offen offset:3072 lds
    s_add_u32 s58, s58, 12288
    ds_read_b32 v0, v15 offset:0
    v_add_f32 v184, 1.0, v184
    v_add_f32 v185, 1.0, v185
    v_add_f32 v186, 1.0, v186
    v_add_f32 v187, 1.0, v187
    v_add_f32 v188, 1.0, v188
    v_add_f32 v189, 1.0, v189
    v_add_f32 v190, 1.0, v190
    v_add_f32 v191, 1.0, v191
    v_mul_f32 v64, v64, v176
    v_mul_f32 v65, v65, v177
    v_mul_f32 v66, v66, v178
    v_mul_f32 v67, v67, v179
    v_mul_f32 v68, v68, v180
    v_mul_f32 v69, v69, v181
    v_mul_f32 v70, v70, v182
    v_mul_f32 v71, v71, v183
    v_fmaak_f32 v176, v80, v80, 0x409d30fc
    v_fmaak_f32 v177, v81, v81, 0x409d30fc
    v_fmaak_f32 v178, v82, v82, 0x409d30fc
    v_fmaak_f32 v179, v83, v83, 0x409d30fc
    v_fmaak_f32 v180, v84, v84, 0x409d30fc
    v_fmaak_f32 v181, v85, v85, 0x409d30fc
    v_fmaak_f32 v182, v86, v86, 0x409d30fc
    v_fmaak_f32 v183, v87, v87, 0x409d30fc
    v_mul_f32 v176, v80, v176
    v_mul_f32 v177, v81, v177
    v_mul_f32 v178, v82, v178
    v_mul_f32 v179, v83, v179
    v_mul_f32 v180, v84, v180
    v_mul_f32 v181, v85, v181
    v_mul_f32 v182, v86, v182
    v_mul_f32 v183, v87, v183
    v_add_u32 v4, 49152, v4
    v_add_u32 v5, 49152, v5
    s_setprio 2
    s_waitcnt lgkmcnt(0)
    v_mfma_f32_32x32x16_bf16 v[16:31], v[144:147], v[172:175], v[16:31]
    v_cvt_pk_bf16_f32 v168, v64, v65
    v_cvt_pk_bf16_f32 v169, v66, v67
    v_rcp_f32 v184, v184
    v_rcp_f32 v185, v185
    v_mfma_f32_32x32x16_bf16 v[32:47], v[148:151], v[172:175], v[32:47]
    v_cvt_pk_bf16_f32 v170, v68, v69
    v_cvt_pk_bf16_f32 v171, v70, v71
    v_rcp_f32 v186, v186
    v_rcp_f32 v187, v187
    v_mfma_f32_32x32x16_bf16 v[48:63], v[152:155], v[172:175], v[48:63]
    v_rcp_f32 v188, v188
    v_rcp_f32 v189, v189
    v_rcp_f32 v190, v190
    v_mfma_f32_32x32x16_bf16 v[16:31], v[156:159], v[168:171], v[16:31]
    v_rcp_f32 v191, v191
    v_exp_f32 v176, v176
    v_exp_f32 v177, v177
    v_mfma_f32_32x32x16_bf16 v[32:47], v[160:163], v[168:171], v[32:47]
    v_exp_f32 v178, v178
    v_exp_f32 v179, v179
    v_exp_f32 v180, v180
    v_mfma_f32_32x32x16_bf16 v[48:63], v[164:167], v[168:171], v[48:63]
    v_exp_f32 v181, v181
    v_exp_f32 v182, v182
    v_exp_f32 v183, v183
    v_readfirstlane_b32 s54, v0
    s_setprio 0
    s_add_u32 s54, s54, 0x79797979
    s_andn2_b32 s54, 0x80808080, s54
    s_cbranch_scc0 L_needL10_ok
L_needL10:
    ds_read_b32 v0, v15 offset:0
    s_waitcnt lgkmcnt(0)
    v_readfirstlane_b32 s54, v0
    s_nop 0
    s_add_u32 s54, s54, 0x79797979
    s_andn2_b32 s54, 0x80808080, s54
    s_cbranch_scc1 L_needL10
L_needL10_ok:
    ds_read_b128 v[192:195], v6 offset:768
    ds_read_b128 v[196:199], v6 offset:800
    ds_read_b128 v[200:203], v6 offset:832
    ds_read_b128 v[204:207], v6 offset:864
    ds_read_b64_tr_b16 v[120:121], v4 offset:24576
    ds_read_b64_tr_b16 v[122:123], v4 offset:25600
    ds_read_b64_tr_b16 v[124:125], v4 offset:26624
    ds_read_b64_tr_b16 v[126:127], v4 offset:27648
    ds_read_b64_tr_b16 v[128:129], v4 offset:28672
    ds_read_b64_tr_b16 v[130:131], v4 offset:29696
    ds_read_b64_tr_b16 v[132:133], v4 offset:30720
    ds_read_b64_tr_b16 v[134:135], v4 offset:31744
    ds_read_b64_tr_b16 v[136:137], v4 offset:32768
    ds_read_b64_tr_b16 v[138:139], v4 offset:33792
    ds_read_b64_tr_b16 v[140:141], v4 offset:34816
    ds_read_b64_tr_b16 v[142:143], v4 offset:35840
    s_mov_b32 m0, s61
    s_add_u32 s61, s61, 24576
    buffer_load_dwordx4 v9, s[36:39], s58 offen offset:0 lds
    buffer_load_dwordx4 v9, s[36:39], s58 offen offset:1024 lds
    v_add_f32 v176, 1.0, v176
    v_add_f32 v177, 1.0, v177
    v_add_f32 v178, 1.0, v178
    v_add_f32 v179, 1.0, v179
    v_add_f32 v180, 1.0, v180
    v_add_f32 v181, 1.0, v181
    v_add_f32 v182, 1.0, v182
    v_add_f32 v183, 1.0, v183
    v_mul_f32 v248, v72, v184
    v_mul_f32 v249, v73, v185
    v_mul_f32 v250, v74, v186
    v_mul_f32 v251, v75, v187
    v_mul_f32 v252, v76, v188
    v_mul_f32 v253, v77, v189
    v_mul_f32 v254, v78, v190
    v_mul_f32 v255, v79, v191
    v_fmaak_f32 v184, v88, v88, 0x409d30fc
    v_fmaak_f32 v185, v89, v89, 0x409d30fc
    v_fmaak_f32 v186, v90, v90, 0x409d30fc
    v_fmaak_f32 v187, v91, v91, 0x409d30fc
    v_fmaak_f32 v188, v92, v92, 0x409d30fc
    v_fmaak_f32 v189, v93, v93, 0x409d30fc
    v_fmaak_f32 v190, v94, v94, 0x409d30fc
    v_fmaak_f32 v191, v95, v95, 0x409d30fc
    v_mul_f32 v184, v88, v184
    v_mul_f32 v185, v89, v185
    v_mul_f32 v186, v90, v186
    v_mul_f32 v187, v91, v187
    v_mul_f32 v188, v92, v188
    v_mul_f32 v189, v93, v189
    v_mul_f32 v190, v94, v190
    v_mul_f32 v191, v95, v191
    s_setprio 2
    s_waitcnt lgkmcnt(0)
    v_mfma_f32_32x32x16_bf16 v[64:79], v[120:123], v[96:99], v[192:207]
    v_cvt_pk_bf16_f32 v172, v248, v249
    v_cvt_pk_bf16_f32 v173, v250, v251
    v_rcp_f32 v176, v176
    v_rcp_f32 v177, v177
    v_mfma_f32_32x32x16_bf16 v[64:79], v[124:127], v[100:103], v[64:79]
    v_cvt_pk_bf16_f32 v174, v252, v253
    v_cvt_pk_bf16_f32 v175, v254, v255
    v_rcp_f32 v178, v178
    v_rcp_f32 v179, v179
    v_mfma_f32_32x32x16_bf16 v[64:79], v[128:131], v[104:107], v[64:79]
    v_rcp_f32 v180, v180
    v_rcp_f32 v181, v181
    v_rcp_f32 v182, v182
    v_mfma_f32_32x32x16_bf16 v[64:79], v[132:135], v[108:111], v[64:79]
    v_rcp_f32 v183, v183
    v_exp_f32 v184, v184
    v_exp_f32 v185, v185
    v_mfma_f32_32x32x16_bf16 v[64:79], v[136:139], v[112:115], v[64:79]
    v_exp_f32 v186, v186
    v_exp_f32 v187, v187
    v_exp_f32 v188, v188
    v_mfma_f32_32x32x16_bf16 v[64:79], v[140:143], v[116:119], v[64:79]
    v_exp_f32 v189, v189
    v_exp_f32 v190, v190
    v_exp_f32 v191, v191
    s_setprio 0
    ds_read_b64_tr_b16 v[144:145], v5 offset:15360
    ds_read_b64_tr_b16 v[146:147], v5 offset:16896
    ds_read_b64_tr_b16 v[148:149], v5 offset:15424
    ds_read_b64_tr_b16 v[150:151], v5 offset:16960
    ds_read_b64_tr_b16 v[152:153], v5 offset:15488
    ds_read_b64_tr_b16 v[154:155], v5 offset:17024
    ds_read_b64_tr_b16 v[156:157], v5 offset:18432
    ds_read_b64_tr_b16 v[158:159], v5 offset:19968
    ds_read_b64_tr_b16 v[160:161], v5 offset:18496
    ds_read_b64_tr_b16 v[162:163], v5 offset:20032
    ds_read_b64_tr_b16 v[164:165], v5 offset:18560
    ds_read_b64_tr_b16 v[166:167], v5 offset:20096
    s_waitcnt vmcnt(2)
    ds_write_b8 v14, v3
    buffer_load_dwordx4 v9, s[36:39], s58 offen offset:2048 lds
    v_add_f32 v184, 1.0, v184
    v_add_f32 v185, 1.0, v185
    v_add_f32 v186, 1.0, v186
    v_add_f32 v187, 1.0, v187
    v_add_f32 v188, 1.0, v188
    v_add_f32 v189, 1.0, v189
    v_add_f32 v190, 1.0, v190
    v_add_f32 v191, 1.0, v191
    v_mul_f32 v80, v80, v176
    v_mul_f32 v81, v81, v177
    v_mul_f32 v82, v82, v178
    v_mul_f32 v83, v83, v179
    v_mul_f32 v84, v84, v180
    v_mul_f32 v85, v85, v181
    v_mul_f32 v86, v86, v182
    v_mul_f32 v87, v87, v183
    v_fmaak_f32 v176, v64, v64, 0x409d30fc
    v_fmaak_f32 v177, v65, v65, 0x409d30fc
    v_fmaak_f32 v178, v66, v66, 0x409d30fc
    v_fmaak_f32 v179, v67, v67, 0x409d30fc
    v_fmaak_f32 v180, v68, v68, 0x409d30fc
    v_fmaak_f32 v181, v69, v69, 0x409d30fc
    v_fmaak_f32 v182, v70, v70, 0x409d30fc
    v_fmaak_f32 v183, v71, v71, 0x409d30fc
    v_mul_f32 v176, v64, v176
    v_mul_f32 v177, v65, v177
    v_mul_f32 v178, v66, v178
    v_mul_f32 v179, v67, v179
    v_mul_f32 v180, v68, v180
    v_mul_f32 v181, v69, v181
    v_mul_f32 v182, v70, v182
    v_mul_f32 v183, v71, v183
    v_add_u32 v3, 1, v3
    s_setprio 2
    s_waitcnt lgkmcnt(0)
    v_mfma_f32_32x32x16_bf16 v[16:31], v[144:147], v[172:175], v[16:31]
    v_cvt_pk_bf16_f32 v168, v80, v81
    v_cvt_pk_bf16_f32 v169, v82, v83
    v_rcp_f32 v184, v184
    v_rcp_f32 v185, v185
    v_mfma_f32_32x32x16_bf16 v[32:47], v[148:151], v[172:175], v[32:47]
    v_cvt_pk_bf16_f32 v170, v84, v85
    v_cvt_pk_bf16_f32 v171, v86, v87
    v_rcp_f32 v186, v186
    v_rcp_f32 v187, v187
    v_mfma_f32_32x32x16_bf16 v[48:63], v[152:155], v[172:175], v[48:63]
    v_rcp_f32 v188, v188
    v_rcp_f32 v189, v189
    v_rcp_f32 v190, v190
    v_mfma_f32_32x32x16_bf16 v[16:31], v[156:159], v[168:171], v[16:31]
    v_rcp_f32 v191, v191
    v_exp_f32 v176, v176
    v_exp_f32 v177, v177
    v_mfma_f32_32x32x16_bf16 v[32:47], v[160:163], v[168:171], v[32:47]
    v_exp_f32 v178, v178
    v_exp_f32 v179, v179
    v_exp_f32 v180, v180
    v_mfma_f32_32x32x16_bf16 v[48:63], v[164:167], v[168:171], v[48:63]
    v_exp_f32 v181, v181
    v_exp_f32 v182, v182
    v_exp_f32 v183, v183
    s_setprio 0
    ds_read_b128 v[192:195], v6 offset:896
    ds_read_b128 v[196:199], v6 offset:928
    ds_read_b128 v[200:203], v6 offset:960
    ds_read_b128 v[204:207], v6 offset:992
    ds_read_b64_tr_b16 v[120:121], v4 offset:25088
    ds_read_b64_tr_b16 v[122:123], v4 offset:26112
    ds_read_b64_tr_b16 v[124:125], v4 offset:27136
    ds_read_b64_tr_b16 v[126:127], v4 offset:28160
    ds_read_b64_tr_b16 v[128:129], v4 offset:29184
    ds_read_b64_tr_b16 v[130:131], v4 offset:30208
    ds_read_b64_tr_b16 v[132:133], v4 offset:31232
    ds_read_b64_tr_b16 v[134:135], v4 offset:32256
    ds_read_b64_tr_b16 v[136:137], v4 offset:33280
    ds_read_b64_tr_b16 v[138:139], v4 offset:34304
    ds_read_b64_tr_b16 v[140:141], v4 offset:35328
    ds_read_b64_tr_b16 v[142:143], v4 offset:36352
    buffer_load_dwordx4 v9, s[36:39], s58 offen offset:3072 lds
    s_add_u32 s58, s58, 12288
    ds_read_b32 v0, v15 offset:4
    v_add_f32 v176, 1.0, v176
    v_add_f32 v177, 1.0, v177
    v_add_f32 v178, 1.0, v178
    v_add_f32 v179, 1.0, v179
    v_add_f32 v180, 1.0, v180
    v_add_f32 v181, 1.0, v181
    v_add_f32 v182, 1.0, v182
    v_add_f32 v183, 1.0, v183
    v_mul_f32 v248, v88, v184
    v_mul_f32 v249, v89, v185
    v_mul_f32 v250, v90, v186
    v_mul_f32 v251, v91, v187
    v_mul_f32 v252, v92, v188
    v_mul_f32 v253, v93, v189
    v_mul_f32 v254, v94, v190
    v_mul_f32 v255, v95, v191
    v_fmaak_f32 v184, v72, v72, 0x409d30fc
    v_fmaak_f32 v185, v73, v73, 0x409d30fc
    v_fmaak_f32 v186, v74, v74, 0x409d30fc
    v_fmaak_f32 v187, v75, v75, 0x409d30fc
    v_fmaak_f32 v188, v76, v76, 0x409d30fc
    v_fmaak_f32 v189, v77, v77, 0x409d30fc
    v_fmaak_f32 v190, v78, v78, 0x409d30fc
    v_fmaak_f32 v191, v79, v79, 0x409d30fc
    v_mul_f32 v184, v72, v184
    v_mul_f32 v185, v73, v185
    v_mul_f32 v186, v74, v186
    v_mul_f32 v187, v75, v187
    v_mul_f32 v188, v76, v188
    v_mul_f32 v189, v77, v189
    v_mul_f32 v190, v78, v190
    v_mul_f32 v191, v79, v191
    s_setprio 2
    s_waitcnt lgkmcnt(0)
    v_mfma_f32_32x32x16_bf16 v[80:95], v[120:123], v[96:99], v[192:207]
    v_cvt_pk_bf16_f32 v172, v248, v249
    v_cvt_pk_bf16_f32 v173, v250, v251
    v_rcp_f32 v176, v176
    v_rcp_f32 v177, v177
    v_mfma_f32_32x32x16_bf16 v[80:95], v[124:127], v[100:103], v[80:95]
    v_cvt_pk_bf16_f32 v174, v252, v253
    v_cvt_pk_bf16_f32 v175, v254, v255
    v_rcp_f32 v178, v178
    v_rcp_f32 v179, v179
    v_mfma_f32_32x32x16_bf16 v[80:95], v[128:131], v[104:107], v[80:95]
    v_rcp_f32 v180, v180
    v_rcp_f32 v181, v181
    v_rcp_f32 v182, v182
    v_mfma_f32_32x32x16_bf16 v[80:95], v[132:135], v[108:111], v[80:95]
    v_rcp_f32 v183, v183
    v_exp_f32 v184, v184
    v_exp_f32 v185, v185
    v_mfma_f32_32x32x16_bf16 v[80:95], v[136:139], v[112:115], v[80:95]
    v_exp_f32 v186, v186
    v_exp_f32 v187, v187
    v_exp_f32 v188, v188
    v_mfma_f32_32x32x16_bf16 v[80:95], v[140:143], v[116:119], v[80:95]
    v_exp_f32 v189, v189
    v_exp_f32 v190, v190
    v_exp_f32 v191, v191
    v_readfirstlane_b32 s54, v0
    s_setprio 0
    s_add_u32 s54, s54, 0x79797979
    s_andn2_b32 s54, 0x80808080, s54
    s_cbranch_scc0 L_needL13_ok
L_needL13:
    ds_read_b32 v0, v15 offset:4
    s_waitcnt lgkmcnt(0)
    v_readfirstlane_b32 s54, v0
    s_nop 0
    s_add_u32 s54, s54, 0x79797979
    s_andn2_b32 s54, 0x80808080, s54
    s_cbranch_scc1 L_needL13
L_needL13_ok:
    ds_read_b64_tr_b16 v[144:145], v5 offset:21504
    ds_read_b64_tr_b16 v[146:147], v5 offset:23040
    ds_read_b64_tr_b16 v[148:149], v5 offset:21568
    ds_read_b64_tr_b16 v[150:151], v5 offset:23104
    ds_read_b64_tr_b16 v[152:153], v5 offset:21632
    ds_read_b64_tr_b16 v[154:155], v5 offset:23168
    ds_read_b64_tr_b16 v[156:157], v5 offset:36864
    ds_read_b64_tr_b16 v[158:159], v5 offset:38400
    ds_read_b64_tr_b16 v[160:161], v5 offset:36928
    ds_read_b64_tr_b16 v[162:163], v5 offset:38464
    ds_read_b64_tr_b16 v[164:165], v5 offset:36992
    ds_read_b64_tr_b16 v[166:167], v5 offset:38528
    s_mov_b32 m0, s61
    s_add_u32 s61, s61, 24576
    buffer_load_dwordx4 v9, s[36:39], s58 offen offset:0 lds
    buffer_load_dwordx4 v9, s[36:39], s58 offen offset:1024 lds
    ds_read_b32 v0, v15 offset:0
    v_add_f32 v184, 1.0, v184
    v_add_f32 v185, 1.0, v185
    v_add_f32 v186, 1.0, v186
    v_add_f32 v187, 1.0, v187
    v_add_f32 v188, 1.0, v188
    v_add_f32 v189, 1.0, v189
    v_add_f32 v190, 1.0, v190
    v_add_f32 v191, 1.0, v191
    v_mul_f32 v64, v64, v176
    v_mul_f32 v65, v65, v177
    v_mul_f32 v66, v66, v178
    v_mul_f32 v67, v67, v179
    v_mul_f32 v68, v68, v180
    v_mul_f32 v69, v69, v181
    v_mul_f32 v70, v70, v182
    v_mul_f32 v71, v71, v183
    v_fmaak_f32 v176, v80, v80, 0x409d30fc
    v_fmaak_f32 v177, v81, v81, 0x409d30fc
    v_fmaak_f32 v178, v82, v82, 0x409d30fc
    v_fmaak_f32 v179, v83, v83, 0x409d30fc
    v_fmaak_f32 v180, v84, v84, 0x409d30fc
    v_fmaak_f32 v181, v85, v85, 0x409d30fc
    v_fmaak_f32 v182, v86, v86, 0x409d30fc
    v_fmaak_f32 v183, v87, v87, 0x409d30fc
    v_mul_f32 v176, v80, v176
    v_mul_f32 v177, v81, v177
    v_mul_f32 v178, v82, v178
    v_mul_f32 v179, v83, v179
    v_mul_f32 v180, v84, v180
    v_mul_f32 v181, v85, v181
    v_mul_f32 v182, v86, v182
    v_mul_f32 v183, v87, v183
    s_setprio 2
    s_waitcnt lgkmcnt(0)
    v_mfma_f32_32x32x16_bf16 v[16:31], v[144:147], v[172:175], v[16:31]
    v_cvt_pk_bf16_f32 v168, v64, v65
    v_cvt_pk_bf16_f32 v169, v66, v67
    v_rcp_f32 v184, v184
    v_rcp_f32 v185, v185
    v_mfma_f32_32x32x16_bf16 v[32:47], v[148:151], v[172:175], v[32:47]
    v_cvt_pk_bf16_f32 v170, v68, v69
    v_cvt_pk_bf16_f32 v171, v70, v71
    v_rcp_f32 v186, v186
    v_rcp_f32 v187, v187
    v_mfma_f32_32x32x16_bf16 v[48:63], v[152:155], v[172:175], v[48:63]
    v_rcp_f32 v188, v188
    v_rcp_f32 v189, v189
    v_rcp_f32 v190, v190
    v_mfma_f32_32x32x16_bf16 v[16:31], v[156:159], v[168:171], v[16:31]
    v_rcp_f32 v191, v191
    v_exp_f32 v176, v176
    v_exp_f32 v177, v177
    v_mfma_f32_32x32x16_bf16 v[32:47], v[160:163], v[168:171], v[32:47]
    v_exp_f32 v178, v178
    v_exp_f32 v179, v179
    v_exp_f32 v180, v180
    v_mfma_f32_32x32x16_bf16 v[48:63], v[164:167], v[168:171], v[48:63]
    v_exp_f32 v181, v181
    v_exp_f32 v182, v182
    v_exp_f32 v183, v183
    v_readfirstlane_b32 s54, v0
    s_setprio 0
    s_add_u32 s54, s54, 0x78787878
    s_andn2_b32 s54, 0x80808080, s54
    s_cbranch_scc0 L_needL14_ok
L_needL14:
    ds_read_b32 v0, v15 offset:0
    s_waitcnt lgkmcnt(0)
    v_readfirstlane_b32 s54, v0
    s_nop 0
    s_add_u32 s54, s54, 0x78787878
    s_andn2_b32 s54, 0x80808080, s54
    s_cbranch_scc1 L_needL14
L_needL14_ok:
    ds_read_b128 v[192:195], v6 offset:1024
    ds_read_b128 v[196:199], v6 offset:1056
    ds_read_b128 v[200:203], v6 offset:1088
    ds_read_b128 v[204:207], v6 offset:1120
    ds_read_b64_tr_b16 v[120:121], v4 offset:49152
    ds_read_b64_tr_b16 v[122:123], v4 offset:50176
    ds_read_b64_tr_b16 v[124:125], v4 offset:51200
    ds_read_b64_tr_b16 v[126:127], v4 offset:52224
    ds_read_b64_tr_b16 v[128:129], v4 offset:53248
    ds_read_b64_tr_b16 v[130:131], v4 offset:54272
    ds_read_b64_tr_b16 v[132:133], v4 offset:55296
    ds_read_b64_tr_b16 v[134:135], v4 offset:56320
    ds_read_b64_tr_b16 v[136:137], v4 offset:57344
    ds_read_b64_tr_b16 v[138:139], v4 offset:58368
    ds_read_b64_tr_b16 v[140:141], v4 offset:59392
    ds_read_b64_tr_b16 v[142:143], v4 offset:60416
    s_waitcnt vmcnt(2)
    ds_write_b8 v14, v3
    buffer_load_dwordx4 v9, s[36:39], s58 offen offset:2048 lds
    v_add_f32 v176, 1.0, v176
    v_add_f32 v177, 1.0, v177
    v_add_f32 v178, 1.0, v178
    v_add_f32 v179, 1.0, v179
    v_add_f32 v180, 1.0, v180
    v_add_f32 v181, 1.0, v181
    v_add_f32 v182, 1.0, v182
    v_add_f32 v183, 1.0, v183
    v_mul_f32 v248, v72, v184
    v_mul_f32 v249, v73, v185
    v_mul_f32 v250, v74, v186
    v_mul_f32 v251, v75, v187
    v_mul_f32 v252, v76, v188
    v_mul_f32 v253, v77, v189
    v_mul_f32 v254, v78, v190
    v_mul_f32 v255, v79, v191
    v_fmaak_f32 v184, v88, v88, 0x409d30fc
    v_fmaak_f32 v185, v89, v89, 0x409d30fc
    v_fmaak_f32 v186, v90, v90, 0x409d30fc
    v_fmaak_f32 v187, v91, v91, 0x409d30fc
    v_fmaak_f32 v188, v92, v92, 0x409d30fc
    v_fmaak_f32 v189, v93, v93, 0x409d30fc
    v_fmaak_f32 v190, v94, v94, 0x409d30fc
    v_fmaak_f32 v191, v95, v95, 0x409d30fc
    v_mul_f32 v184, v88, v184
    v_mul_f32 v185, v89, v185
    v_mul_f32 v186, v90, v186
    v_mul_f32 v187, v91, v187
    v_mul_f32 v188, v92, v188
    v_mul_f32 v189, v93, v189
    v_mul_f32 v190, v94, v190
    v_mul_f32 v191, v95, v191
    v_add_u32 v3, 1, v3
    s_setprio 2
    s_waitcnt lgkmcnt(0)
    v_mfma_f32_32x32x16_bf16 v[64:79], v[120:123], v[96:99], v[192:207]
    v_cvt_pk_bf16_f32 v172, v248, v249
    v_cvt_pk_bf16_f32 v173, v250, v251
    v_rcp_f32 v176, v176
    v_rcp_f32 v177, v177
    v_mfma_f32_32x32x16_bf16 v[64:79], v[124:127], v[100:103], v[64:79]
    v_cvt_pk_bf16_f32 v174, v252, v253
    v_cvt_pk_bf16_f32 v175, v254, v255
    v_rcp_f32 v178, v178
    v_rcp_f32 v179, v179
    v_mfma_f32_32x32x16_bf16 v[64:79], v[128:131], v[104:107], v[64:79]
    v_rcp_f32 v180, v180
    v_rcp_f32 v181, v181
    v_rcp_f32 v182, v182
    v_mfma_f32_32x32x16_bf16 v[64:79], v[132:135], v[108:111], v[64:79]
    v_rcp_f32 v183, v183
    v_exp_f32 v184, v184
    v_exp_f32 v185, v185
    v_mfma_f32_32x32x16_bf16 v[64:79], v[136:139], v[112:115], v[64:79]
    v_exp_f32 v186, v186
    v_exp_f32 v187, v187
    v_exp_f32 v188, v188
    v_mfma_f32_32x32x16_bf16 v[64:79], v[140:143], v[116:119], v[64:79]
    v_exp_f32 v189, v189
    v_exp_f32 v190, v190
    v_exp_f32 v191, v191
    s_setprio 0
    ds_read_b64_tr_b16 v[144:145], v5 offset:39936
    ds_read_b64_tr_b16 v[146:147], v5 offset:41472
    ds_read_b64_tr_b16 v[148:149], v5 offset:40000
    ds_read_b64_tr_b16 v[150:151], v5 offset:41536
    ds_read_b64_tr_b16 v[152:153], v5 offset:40064
    ds_read_b64_tr_b16 v[154:155], v5 offset:41600
    ds_read_b64_tr_b16 v[156:157], v5 offset:43008
    ds_read_b64_tr_b16 v[158:159], v5 offset:44544
    ds_read_b64_tr_b16 v[160:161], v5 offset:43072
    ds_read_b64_tr_b16 v[162:163], v5 offset:44608
    ds_read_b64_tr_b16 v[164:165], v5 offset:43136
    ds_read_b64_tr_b16 v[166:167], v5 offset:44672
    buffer_load_dwordx4 v9, s[36:39], s58 offen offset:3072 lds
    s_add_u32 s58, s58, 12288
    v_add_f32 v184, 1.0, v184
    v_add_f32 v185, 1.0, v185
    v_add_f32 v186, 1.0, v186
    v_add_f32 v187, 1.0, v187
    v_add_f32 v188, 1.0, v188
    v_add_f32 v189, 1.0, v189
    v_add_f32 v190, 1.0, v190
    v_add_f32 v191, 1.0, v191
    v_mul_f32 v80, v80, v176
    v_mul_f32 v81, v81, v177
    v_mul_f32 v82, v82, v178
    v_mul_f32 v83, v83, v179
    v_mul_f32 v84, v84, v180
    v_mul_f32 v85, v85, v181
    v_mul_f32 v86, v86, v182
    v_mul_f32 v87, v87, v183
    v_fmaak_f32 v176, v64, v64, 0x409d30fc
    v_fmaak_f32 v177, v65, v65, 0x409d30fc
    v_fmaak_f32 v178, v66, v66, 0x409d30fc
    v_fmaak_f32 v179, v67, v67, 0x409d30fc
    v_fmaak_f32 v180, v68, v68, 0x409d30fc
    v_fmaak_f32 v181, v69, v69, 0x409d30fc
    v_fmaak_f32 v182, v70, v70, 0x409d30fc
    v_fmaak_f32 v183, v71, v71, 0x409d30fc
    v_mul_f32 v176, v64, v176
    v_mul_f32 v177, v65, v177
    v_mul_f32 v178, v66, v178
    v_mul_f32 v179, v67, v179
    v_mul_f32 v180, v68, v180
    v_mul_f32 v181, v69, v181
    v_mul_f32 v182, v70, v182
    v_mul_f32 v183, v71, v183
    s_setprio 2
    s_waitcnt lgkmcnt(0)
    v_mfma_f32_32x32x16_bf16 v[16:31], v[144:147], v[172:175], v[16:31]
    v_cvt_pk_bf16_f32 v168, v80, v81
    v_cvt_pk_bf16_f32 v169, v82, v83
    v_rcp_f32 v184, v184
    v_rcp_f32 v185, v185
    v_mfma_f32_32x32x16_bf16 v[32:47], v[148:151], v[172:175], v[32:47]
    v_cvt_pk_bf16_f32 v170, v84, v85
    v_cvt_pk_bf16_f32 v171, v86, v87
    v_rcp_f32 v186, v186
    v_rcp_f32 v187, v187
    v_mfma_f32_32x32x16_bf16 v[48:63], v[152:155], v[172:175], v[48:63]
    v_rcp_f32 v188, v188
    v_rcp_f32 v189, v189
    v_rcp_f32 v190, v190
    v_mfma_f32_32x32x16_bf16 v[16:31], v[156:159], v[168:171], v[16:31]
    v_rcp_f32 v191, v191
    v_exp_f32 v176, v176
    v_exp_f32 v177, v177
    v_mfma_f32_32x32x16_bf16 v[32:47], v[160:163], v[168:171], v[32:47]
    v_exp_f32 v178, v178
    v_exp_f32 v179, v179
    v_exp_f32 v180, v180
    v_mfma_f32_32x32x16_bf16 v[48:63], v[164:167], v[168:171], v[48:63]
    v_exp_f32 v181, v181
    v_exp_f32 v182, v182
    v_exp_f32 v183, v183
    s_setprio 0
    ds_read_b128 v[192:195], v6 offset:1152
    ds_read_b128 v[196:199], v6 offset:1184
    ds_read_b128 v[200:203], v6 offset:1216
    ds_read_b128 v[204:207], v6 offset:1248
    ds_read_b64_tr_b16 v[120:121], v4 offset:49664
    ds_read_b64_tr_b16 v[122:123], v4 offset:50688
    ds_read_b64_tr_b16 v[124:125], v4 offset:51712
    ds_read_b64_tr_b16 v[126:127], v4 offset:52736
    ds_read_b64_tr_b16 v[128:129], v4 offset:53760
    ds_read_b64_tr_b16 v[130:131], v4 offset:54784
    ds_read_b64_tr_b16 v[132:133], v4 offset:55808
    ds_read_b64_tr_b16 v[134:135], v4 offset:56832
    ds_read_b64_tr_b16 v[136:137], v4 offset:57856
    ds_read_b64_tr_b16 v[138:139], v4 offset:58880
    ds_read_b64_tr_b16 v[140:141], v4 offset:59904
    ds_read_b64_tr_b16 v[142:143], v4 offset:60928
    ds_read_b32 v0, v15 offset:4
    v_add_f32 v176, 1.0, v176
    v_add_f32 v177, 1.0, v177
    v_add_f32 v178, 1.0, v178
    v_add_f32 v179, 1.0, v179
    v_add_f32 v180, 1.0, v180
    v_add_f32 v181, 1.0, v181
    v_add_f32 v182, 1.0, v182
    v_add_f32 v183, 1.0, v183
    v_mul_f32 v248, v88, v184
    v_mul_f32 v249, v89, v185
    v_mul_f32 v250, v90, v186
    v_mul_f32 v251, v91, v187
    v_mul_f32 v252, v92, v188
    v_mul_f32 v253, v93, v189
    v_mul_f32 v254, v94, v190
    v_mul_f32 v255, v95, v191
    v_fmaak_f32 v184, v72, v72, 0x409d30fc
    v_fmaak_f32 v185, v73, v73, 0x409d30fc
    v_fmaak_f32 v186, v74, v74, 0x409d30fc
    v_fmaak_f32 v187, v75, v75, 0x409d30fc
    v_fmaak_f32 v188, v76, v76, 0x409d30fc
    v_fmaak_f32 v189, v77, v77, 0x409d30fc
    v_fmaak_f32 v190, v78, v78, 0x409d30fc
    v_fmaak_f32 v191, v79, v79, 0x409d30fc
    v_mul_f32 v184, v72, v184
    v_mul_f32 v185, v73, v185
    v_mul_f32 v186, v74, v186
    v_mul_f32 v187, v75, v187
    v_mul_f32 v188, v76, v188
    v_mul_f32 v189, v77, v189
    v_mul_f32 v190, v78, v190
    v_mul_f32 v191, v79, v191
    s_setprio 2
    s_waitcnt lgkmcnt(0)
    v_mfma_f32_32x32x16_bf16 v[80:95], v[120:123], v[96:99], v[192:207]
    v_cvt_pk_bf16_f32 v172, v248, v249
    v_cvt_pk_bf16_f32 v173, v250, v251
    v_rcp_f32 v176, v176
    v_rcp_f32 v177, v177
    v_mfma_f32_32x32x16_bf16 v[80:95], v[124:127], v[100:103], v[80:95]
    v_cvt_pk_bf16_f32 v174, v252, v253
    v_cvt_pk_bf16_f32 v175, v254, v255
    v_rcp_f32 v178, v178
    v_rcp_f32 v179, v179
    v_mfma_f32_32x32x16_bf16 v[80:95], v[128:131], v[104:107], v[80:95]
    v_rcp_f32 v180, v180
    v_rcp_f32 v181, v181
    v_rcp_f32 v182, v182
    v_mfma_f32_32x32x16_bf16 v[80:95], v[132:135], v[108:111], v[80:95]
    v_rcp_f32 v183, v183
    v_exp_f32 v184, v184
    v_exp_f32 v185, v185
    v_mfma_f32_32x32x16_bf16 v[80:95], v[136:139], v[112:115], v[80:95]
    v_exp_f32 v186, v186
    v_exp_f32 v187, v187
    v_exp_f32 v188, v188
    v_mfma_f32_32x32x16_bf16 v[80:95], v[140:143], v[116:119], v[80:95]
    v_exp_f32 v189, v189
    v_exp_f32 v190, v190
    v_exp_f32 v191, v191
    v_readfirstlane_b32 s54, v0
    s_setprio 0
    s_add_u32 s54, s54, 0x78787878
    s_andn2_b32 s54, 0x80808080, s54
    s_cbranch_scc0 L_needL17_ok
L_needL17:
    ds_read_b32 v0, v15 offset:4
    s_waitcnt lgkmcnt(0)
    v_readfirstlane_b32 s54, v0
    s_nop 0
    s_add_u32 s54, s54, 0x78787878
    s_andn2_b32 s54, 0x80808080, s54
    s_cbranch_scc1 L_needL17
L_needL17_ok:
    ds_read_b64_tr_b16 v[144:145], v5 offset:46080
    ds_read_b64_tr_b16 v[146:147], v5 offset:47616
    ds_read_b64_tr_b16 v[148:149], v5 offset:46144
    ds_read_b64_tr_b16 v[150:151], v5 offset:47680
    ds_read_b64_tr_b16 v[152:153], v5 offset:46208
    ds_read_b64_tr_b16 v[154:155], v5 offset:47744
    ds_read_b64_tr_b16 v[156:157], v5 offset:61440
    ds_read_b64_tr_b16 v[158:159], v5 offset:62976
    ds_read_b64_tr_b16 v[160:161], v5 offset:61504
    ds_read_b64_tr_b16 v[162:163], v5 offset:63040
    ds_read_b64_tr_b16 v[164:165], v5 offset:61568
    ds_read_b64_tr_b16 v[166:167], v5 offset:63104
    s_waitcnt vmcnt(0)
    ds_write_b8 v14, v3
    ds_read_b32 v0, v15 offset:0
    v_add_f32 v184, 1.0, v184
    v_add_f32 v185, 1.0, v185
    v_add_f32 v186, 1.0, v186
    v_add_f32 v187, 1.0, v187
    v_add_f32 v188, 1.0, v188
    v_add_f32 v189, 1.0, v189
    v_add_f32 v190, 1.0, v190
    v_add_f32 v191, 1.0, v191
    v_mul_f32 v64, v64, v176
    v_mul_f32 v65, v65, v177
    v_mul_f32 v66, v66, v178
    v_mul_f32 v67, v67, v179
    v_mul_f32 v68, v68, v180
    v_mul_f32 v69, v69, v181
    v_mul_f32 v70, v70, v182
    v_mul_f32 v71, v71, v183
    v_fmaak_f32 v176, v80, v80, 0x409d30fc
    v_fmaak_f32 v177, v81, v81, 0x409d30fc
    v_fmaak_f32 v178, v82, v82, 0x409d30fc
    v_fmaak_f32 v179, v83, v83, 0x409d30fc
    v_fmaak_f32 v180, v84, v84, 0x409d30fc
    v_fmaak_f32 v181, v85, v85, 0x409d30fc
    v_fmaak_f32 v182, v86, v86, 0x409d30fc
    v_fmaak_f32 v183, v87, v87, 0x409d30fc
    v_mul_f32 v176, v80, v176
    v_mul_f32 v177, v81, v177
    v_mul_f32 v178, v82, v178
    v_mul_f32 v179, v83, v179
    v_mul_f32 v180, v84, v180
    v_mul_f32 v181, v85, v181
    v_mul_f32 v182, v86, v182
    v_mul_f32 v183, v87, v183
    v_add_u32 v3, 1, v3
    v_add_u32 v4, 49152, v4
    v_add_u32 v5, 49152, v5
    s_setprio 2
    s_waitcnt lgkmcnt(0)
    v_mfma_f32_32x32x16_bf16 v[16:31], v[144:147], v[172:175], v[16:31]
    v_cvt_pk_bf16_f32 v168, v64, v65
    v_cvt_pk_bf16_f32 v169, v66, v67
    v_rcp_f32 v184, v184
    v_rcp_f32 v185, v185
    v_mfma_f32_32x32x16_bf16 v[32:47], v[148:151], v[172:175], v[32:47]
    v_cvt_pk_bf16_f32 v170, v68, v69
    v_cvt_pk_bf16_f32 v171, v70, v71
    v_rcp_f32 v186, v186
    v_rcp_f32 v187, v187
    v_mfma_f32_32x32x16_bf16 v[48:63], v[152:155], v[172:175], v[48:63]
    v_rcp_f32 v188, v188
    v_rcp_f32 v189, v189
    v_rcp_f32 v190, v190
    v_mfma_f32_32x32x16_bf16 v[16:31], v[156:159], v[168:171], v[16:31]
    v_rcp_f32 v191, v191
    v_exp_f32 v176, v176
    v_exp_f32 v177, v177
    v_mfma_f32_32x32x16_bf16 v[32:47], v[160:163], v[168:171], v[32:47]
    v_exp_f32 v178, v178
    v_exp_f32 v179, v179
    v_exp_f32 v180, v180
    v_mfma_f32_32x32x16_bf16 v[48:63], v[164:167], v[168:171], v[48:63]
    v_exp_f32 v181, v181
    v_exp_f32 v182, v182
    v_exp_f32 v183, v183
    v_readfirstlane_b32 s54, v0
    s_setprio 0
    s_add_u32 s54, s54, 0x77777777
    s_andn2_b32 s54, 0x80808080, s54
    s_cbranch_scc0 L_needL18_ok
L_needL18:
    ds_read_b32 v0, v15 offset:0
    s_waitcnt lgkmcnt(0)
    v_readfirstlane_b32 s54, v0
    s_nop 0
    s_add_u32 s54, s54, 0x77777777
    s_andn2_b32 s54, 0x80808080, s54
    s_cbranch_scc1 L_needL18
L_needL18_ok:
    ds_read_b128 v[192:195], v6 offset:1280
    ds_read_b128 v[196:199], v6 offset:1312
    ds_read_b128 v[200:203], v6 offset:1344
    ds_read_b128 v[204:207], v6 offset:1376
    ds_read_b64_tr_b16 v[120:121], v4 offset:24576
    ds_read_b64_tr_b16 v[122:123], v4 offset:25600
    ds_read_b64_tr_b16 v[124:125], v4 offset:26624
    ds_read_b64_tr_b16 v[126:127], v4 offset:27648
    ds_read_b64_tr_b16 v[128:129], v4 offset:28672
    ds_read_b64_tr_b16 v[130:131], v4 offset:29696
    ds_read_b64_tr_b16 v[132:133], v4 offset:30720
    ds_read_b64_tr_b16 v[134:135], v4 offset:31744
    ds_read_b64_tr_b16 v[136:137], v4 offset:32768
    ds_read_b64_tr_b16 v[138:139], v4 offset:33792
    ds_read_b64_tr_b16 v[140:141], v4 offset:34816
    ds_read_b64_tr_b16 v[142:143], v4 offset:35840
    v_add_f32 v176, 1.0, v176
    v_add_f32 v177, 1.0, v177
    v_add_f32 v178, 1.0, v178
    v_add_f32 v179, 1.0, v179
    v_add_f32 v180, 1.0, v180
    v_add_f32 v181, 1.0, v181
    v_add_f32 v182, 1.0, v182
    v_add_f32 v183, 1.0, v183
    v_mul_f32 v248, v72, v184
    v_mul_f32 v249, v73, v185
    v_mul_f32 v250, v74, v186
    v_mul_f32 v251, v75, v187
    v_mul_f32 v252, v76, v188
    v_mul_f32 v253, v77, v189
    v_mul_f32 v254, v78, v190
    v_mul_f32 v255, v79, v191
    v_fmaak_f32 v184, v88, v88, 0x409d30fc
    v_fmaak_f32 v185, v89, v89, 0x409d30fc
    v_fmaak_f32 v186, v90, v90, 0x409d30fc
    v_fmaak_f32 v187, v91, v91, 0x409d30fc
    v_fmaak_f32 v188, v92, v92, 0x409d30fc
    v_fmaak_f32 v189, v93, v93, 0x409d30fc
    v_fmaak_f32 v190, v94, v94, 0x409d30fc
    v_fmaak_f32 v191, v95, v95, 0x409d30fc
    v_mul_f32 v184, v88, v184
    v_mul_f32 v185, v89, v185
    v_mul_f32 v186, v90, v186
    v_mul_f32 v187, v91, v187
    v_mul_f32 v188, v92, v188
    v_mul_f32 v189, v93, v189
    v_mul_f32 v190, v94, v190
    v_mul_f32 v191, v95, v191
    s_setprio 2
    s_waitcnt lgkmcnt(0)
    v_mfma_f32_32x32x16_bf16 v[64:79], v[120:123], v[96:99], v[192:207]
    v_cvt_pk_bf16_f32 v172, v248, v249
    v_cvt_pk_bf16_f32 v173, v250, v251
    v_rcp_f32 v176, v176
    v_rcp_f32 v177, v177
    v_mfma_f32_32x32x16_bf16 v[64:79], v[124:127], v[100:103], v[64:79]
    v_cvt_pk_bf16_f32 v174, v252, v253
    v_cvt_pk_bf16_f32 v175, v254, v255
    v_rcp_f32 v178, v178
    v_rcp_f32 v179, v179
    v_mfma_f32_32x32x16_bf16 v[64:79], v[128:131], v[104:107], v[64:79]
    v_rcp_f32 v180, v180
    v_rcp_f32 v181, v181
    v_rcp_f32 v182, v182
    v_mfma_f32_32x32x16_bf16 v[64:79], v[132:135], v[108:111], v[64:79]
    v_rcp_f32 v183, v183
    v_exp_f32 v184, v184
    v_exp_f32 v185, v185
    v_mfma_f32_32x32x16_bf16 v[64:79], v[136:139], v[112:115], v[64:79]
    v_exp_f32 v186, v186
    v_exp_f32 v187, v187
    v_exp_f32 v188, v188
    v_mfma_f32_32x32x16_bf16 v[64:79], v[140:143], v[116:119], v[64:79]
    v_exp_f32 v189, v189
    v_exp_f32 v190, v190
    v_exp_f32 v191, v191
    s_setprio 0
    ds_read_b64_tr_b16 v[144:145], v5 offset:15360
    ds_read_b64_tr_b16 v[146:147], v5 offset:16896
    ds_read_b64_tr_b16 v[148:149], v5 offset:15424
    ds_read_b64_tr_b16 v[150:151], v5 offset:16960
    ds_read_b64_tr_b16 v[152:153], v5 offset:15488
    ds_read_b64_tr_b16 v[154:155], v5 offset:17024
    ds_read_b64_tr_b16 v[156:157], v5 offset:18432
    ds_read_b64_tr_b16 v[158:159], v5 offset:19968
    ds_read_b64_tr_b16 v[160:161], v5 offset:18496
    ds_read_b64_tr_b16 v[162:163], v5 offset:20032
    ds_read_b64_tr_b16 v[164:165], v5 offset:18560
    ds_read_b64_tr_b16 v[166:167], v5 offset:20096
    v_add_f32 v184, 1.0, v184
    v_add_f32 v185, 1.0, v185
    v_add_f32 v186, 1.0, v186
    v_add_f32 v187, 1.0, v187
    v_add_f32 v188, 1.0, v188
    v_add_f32 v189, 1.0, v189
    v_add_f32 v190, 1.0, v190
    v_add_f32 v191, 1.0, v191
    v_mul_f32 v80, v80, v176
    v_mul_f32 v81, v81, v177
    v_mul_f32 v82, v82, v178
    v_mul_f32 v83, v83, v179
    v_mul_f32 v84, v84, v180
    v_mul_f32 v85, v85, v181
    v_mul_f32 v86, v86, v182
    v_mul_f32 v87, v87, v183
    v_fmaak_f32 v176, v64, v64, 0x409d30fc
    v_fmaak_f32 v177, v65, v65, 0x409d30fc
    v_fmaak_f32 v178, v66, v66, 0x409d30fc
    v_fmaak_f32 v179, v67, v67, 0x409d30fc
    v_fmaak_f32 v180, v68, v68, 0x409d30fc
    v_fmaak_f32 v181, v69, v69, 0x409d30fc
    v_fmaak_f32 v182, v70, v70, 0x409d30fc
    v_fmaak_f32 v183, v71, v71, 0x409d30fc
    v_mul_f32 v176, v64, v176
    v_mul_f32 v177, v65, v177
    v_mul_f32 v178, v66, v178
    v_mul_f32 v179, v67, v179
    v_mul_f32 v180, v68, v180
    v_mul_f32 v181, v69, v181
    v_mul_f32 v182, v70, v182
    v_mul_f32 v183, v71, v183
    s_setprio 2
    s_waitcnt lgkmcnt(0)
    v_mfma_f32_32x32x16_bf16 v[16:31], v[144:147], v[172:175], v[16:31]
    v_cvt_pk_bf16_f32 v168, v80, v81
    v_cvt_pk_bf16_f32 v169, v82, v83
    v_rcp_f32 v184, v184
    v_rcp_f32 v185, v185
    v_mfma_f32_32x32x16_bf16 v[32:47], v[148:151], v[172:175], v[32:47]
    v_cvt_pk_bf16_f32 v170, v84, v85
    v_cvt_pk_bf16_f32 v171, v86, v87
    v_rcp_f32 v186, v186
    v_rcp_f32 v187, v187
    v_mfma_f32_32x32x16_bf16 v[48:63], v[152:155], v[172:175], v[48:63]
    v_rcp_f32 v188, v188
    v_rcp_f32 v189, v189
    v_rcp_f32 v190, v190
    v_mfma_f32_32x32x16_bf16 v[16:31], v[156:159], v[168:171], v[16:31]
    v_rcp_f32 v191, v191
    v_exp_f32 v176, v176
    v_exp_f32 v177, v177
    v_mfma_f32_32x32x16_bf16 v[32:47], v[160:163], v[168:171], v[32:47]
    v_exp_f32 v178, v178
    v_exp_f32 v179, v179
    v_exp_f32 v180, v180
    v_mfma_f32_32x32x16_bf16 v[48:63], v[164:167], v[168:171], v[48:63]
    v_exp_f32 v181, v181
    v_exp_f32 v182, v182
    v_exp_f32 v183, v183
    s_setprio 0
    ds_read_b128 v[192:195], v6 offset:1408
    ds_read_b128 v[196:199], v6 offset:1440
    ds_read_b128 v[200:203], v6 offset:1472
    ds_read_b128 v[204:207], v6 offset:1504
    ds_read_b64_tr_b16 v[120:121], v4 offset:25088
    ds_read_b64_tr_b16 v[122:123], v4 offset:26112
    ds_read_b64_tr_b16 v[124:125], v4 offset:27136
    ds_read_b64_tr_b16 v[126:127], v4 offset:28160
    ds_read_b64_tr_b16 v[128:129], v4 offset:29184
    ds_read_b64_tr_b16 v[130:131], v4 offset:30208
    ds_read_b64_tr_b16 v[132:133], v4 offset:31232
    ds_read_b64_tr_b16 v[134:135], v4 offset:32256
    ds_read_b64_tr_b16 v[136:137], v4 offset:33280
    ds_read_b64_tr_b16 v[138:139], v4 offset:34304
    ds_read_b64_tr_b16 v[140:141], v4 offset:35328
    ds_read_b64_tr_b16 v[142:143], v4 offset:36352
    ds_read_b32 v0, v15 offset:4
    v_add_f32 v176, 1.0, v176
    v_add_f32 v177, 1.0, v177
    v_add_f32 v178, 1.0, v178
    v_add_f32 v179, 1.0, v179
    v_add_f32 v180, 1.0, v180
    v_add_f32 v181, 1.0, v181
    v_add_f32 v182, 1.0, v182
    v_add_f32 v183, 1.0, v183
    v_mul_f32 v248, v88, v184
    v_mul_f32 v249, v89, v185
    v_mul_f32 v250, v90, v186
    v_mul_f32 v251, v91, v187
    v_mul_f32 v252, v92, v188
    v_mul_f32 v253, v93, v189
    v_mul_f32 v254, v94, v190
    v_mul_f32 v255, v95, v191
    v_fmaak_f32 v184, v72, v72, 0x409d30fc
    v_fmaak_f32 v185, v73, v73, 0x409d30fc
    v_fmaak_f32 v186, v74, v74, 0x409d30fc
    v_fmaak_f32 v187, v75, v75, 0x409d30fc
    v_fmaak_f32 v188, v76, v76, 0x409d30fc
    v_fmaak_f32 v189, v77, v77, 0x409d30fc
    v_fmaak_f32 v190, v78, v78, 0x409d30fc
    v_fmaak_f32 v191, v79, v79, 0x409d30fc
    v_mul_f32 v184, v72, v184
    v_mul_f32 v185, v73, v185
    v_mul_f32 v186, v74, v186
    v_mul_f32 v187, v75, v187
    v_mul_f32 v188, v76, v188
    v_mul_f32 v189, v77, v189
    v_mul_f32 v190, v78, v190
    v_mul_f32 v191, v79, v191
    s_setprio 2
    s_waitcnt lgkmcnt(0)
    v_mfma_f32_32x32x16_bf16 v[80:95], v[120:123], v[96:99], v[192:207]
    v_cvt_pk_bf16_f32 v172, v248, v249
    v_cvt_pk_bf16_f32 v173, v250, v251
    v_rcp_f32 v176, v176
    v_rcp_f32 v177, v177
    v_mfma_f32_32x32x16_bf16 v[80:95], v[124:127], v[100:103], v[80:95]
    v_cvt_pk_bf16_f32 v174, v252, v253
    v_cvt_pk_bf16_f32 v175, v254, v255
    v_rcp_f32 v178, v178
    v_rcp_f32 v179, v179
    v_mfma_f32_32x32x16_bf16 v[80:95], v[128:131], v[104:107], v[80:95]
    v_rcp_f32 v180, v180
    v_rcp_f32 v181, v181
    v_rcp_f32 v182, v182
    v_mfma_f32_32x32x16_bf16 v[80:95], v[132:135], v[108:111], v[80:95]
    v_rcp_f32 v183, v183
    v_exp_f32 v184, v184
    v_exp_f32 v185, v185
    v_mfma_f32_32x32x16_bf16 v[80:95], v[136:139], v[112:115], v[80:95]
    v_exp_f32 v186, v186
    v_exp_f32 v187, v187
    v_exp_f32 v188, v188
    v_mfma_f32_32x32x16_bf16 v[80:95], v[140:143], v[116:119], v[80:95]
    v_exp_f32 v189, v189
    v_exp_f32 v190, v190
    v_exp_f32 v191, v191
    v_readfirstlane_b32 s54, v0
    s_setprio 0
    s_add_u32 s54, s54, 0x77777777
    s_andn2_b32 s54, 0x80808080, s54
    s_cbranch_scc0 L_needL21_ok
L_needL21:
    ds_read_b32 v0, v15 offset:4
    s_waitcnt lgkmcnt(0)
    v_readfirstlane_b32 s54, v0
    s_nop 0
    s_add_u32 s54, s54, 0x77777777
    s_andn2_b32 s54, 0x80808080, s54
    s_cbranch_scc1 L_needL21
L_needL21_ok:
    ds_read_b64_tr_b16 v[144:145], v5 offset:21504
    ds_read_b64_tr_b16 v[146:147], v5 offset:23040
    ds_read_b64_tr_b16 v[148:149], v5 offset:21568
    ds_read_b64_tr_b16 v[150:151], v5 offset:23104
    ds_read_b64_tr_b16 v[152:153], v5 offset:21632
    ds_read_b64_tr_b16 v[154:155], v5 offset:23168
    ds_read_b64_tr_b16 v[156:157], v5 offset:36864
    ds_read_b64_tr_b16 v[158:159], v5 offset:38400
    ds_read_b64_tr_b16 v[160:161], v5 offset:36928
    ds_read_b64_tr_b16 v[162:163], v5 offset:38464
    ds_read_b64_tr_b16 v[164:165], v5 offset:36992
    ds_read_b64_tr_b16 v[166:167], v5 offset:38528
    v_add_f32 v184, 1.0, v184
    v_add_f32 v185, 1.0, v185
    v_add_f32 v186, 1.0, v186
    v_add_f32 v187, 1.0, v187
    v_add_f32 v188, 1.0, v188
    v_add_f32 v189, 1.0, v189
    v_add_f32 v190, 1.0, v190
    v_add_f32 v191, 1.0, v191
    v_mul_f32 v64, v64, v176
    v_mul_f32 v65, v65, v177
    v_mul_f32 v66, v66, v178
    v_mul_f32 v67, v67, v179
    v_mul_f32 v68, v68, v180
    v_mul_f32 v69, v69, v181
    v_mul_f32 v70, v70, v182
    v_mul_f32 v71, v71, v183
    v_fmaak_f32 v176, v80, v80, 0x409d30fc
    v_fmaak_f32 v177, v81, v81, 0x409d30fc
    v_fmaak_f32 v178, v82, v82, 0x409d30fc
    v_fmaak_f32 v179, v83, v83, 0x409d30fc
    v_fmaak_f32 v180, v84, v84, 0x409d30fc
    v_fmaak_f32 v181, v85, v85, 0x409d30fc
    v_fmaak_f32 v182, v86, v86, 0x409d30fc
    v_fmaak_f32 v183, v87, v87, 0x409d30fc
    v_mul_f32 v176, v80, v176
    v_mul_f32 v177, v81, v177
    v_mul_f32 v178, v82, v178
    v_mul_f32 v179, v83, v179
    v_mul_f32 v180, v84, v180
    v_mul_f32 v181, v85, v181
    v_mul_f32 v182, v86, v182
    v_mul_f32 v183, v87, v183
    s_setprio 2
    s_waitcnt lgkmcnt(0)
    v_mfma_f32_32x32x16_bf16 v[16:31], v[144:147], v[172:175], v[16:31]
    v_cvt_pk_bf16_f32 v168, v64, v65
    v_cvt_pk_bf16_f32 v169, v66, v67
    v_rcp_f32 v184, v184
    v_rcp_f32 v185, v185
    v_mfma_f32_32x32x16_bf16 v[32:47], v[148:151], v[172:175], v[32:47]
    v_cvt_pk_bf16_f32 v170, v68, v69
    v_cvt_pk_bf16_f32 v171, v70, v71
    v_rcp_f32 v186, v186
    v_rcp_f32 v187, v187
    v_mfma_f32_32x32x16_bf16 v[48:63], v[152:155], v[172:175], v[48:63]
    v_rcp_f32 v188, v188
    v_rcp_f32 v189, v189
    v_rcp_f32 v190, v190
    v_mfma_f32_32x32x16_bf16 v[16:31], v[156:159], v[168:171], v[16:31]
    v_rcp_f32 v191, v191
    v_exp_f32 v176, v176
    v_exp_f32 v177, v177
    v_mfma_f32_32x32x16_bf16 v[32:47], v[160:163], v[168:171], v[32:47]
    v_exp_f32 v178, v178
    v_exp_f32 v179, v179
    v_exp_f32 v180, v180
    v_mfma_f32_32x32x16_bf16 v[48:63], v[164:167], v[168:171], v[48:63]
    v_exp_f32 v181, v181
    v_exp_f32 v182, v182
    v_exp_f32 v183, v183
    s_setprio 0
    ds_read_b64_tr_b16 v[120:121], v5 offset:39936
    ds_read_b64_tr_b16 v[122:123], v5 offset:41472
    ds_read_b64_tr_b16 v[124:125], v5 offset:40000
    ds_read_b64_tr_b16 v[126:127], v5 offset:41536
    ds_read_b64_tr_b16 v[128:129], v5 offset:40064
    ds_read_b64_tr_b16 v[130:131], v5 offset:41600
    v_add_f32 v176, 1.0, v176
    v_add_f32 v177, 1.0, v177
    v_add_f32 v178, 1.0, v178
    v_add_f32 v179, 1.0, v179
    v_add_f32 v180, 1.0, v180
    v_add_f32 v181, 1.0, v181
    v_add_f32 v182, 1.0, v182
    v_add_f32 v183, 1.0, v183
    v_mul_f32 v72, v72, v184
    v_mul_f32 v73, v73, v185
    v_mul_f32 v74, v74, v186
    v_mul_f32 v75, v75, v187
    v_mul_f32 v76, v76, v188
    v_mul_f32 v77, v77, v189
    v_mul_f32 v78, v78, v190
    v_mul_f32 v79, v79, v191
    v_fmaak_f32 v184, v88, v88, 0x409d30fc
    v_fmaak_f32 v185, v89, v89, 0x409d30fc
    v_fmaak_f32 v186, v90, v90, 0x409d30fc
    v_fmaak_f32 v187, v91, v91, 0x409d30fc
    v_fmaak_f32 v188, v92, v92, 0x409d30fc
    v_fmaak_f32 v189, v93, v93, 0x409d30fc
    v_fmaak_f32 v190, v94, v94, 0x409d30fc
    v_fmaak_f32 v191, v95, v95, 0x409d30fc
    v_mul_f32 v184, v88, v184
    v_mul_f32 v185, v89, v185
    v_mul_f32 v186, v90, v186
    v_mul_f32 v187, v91, v187
    v_mul_f32 v188, v92, v188
    v_mul_f32 v189, v93, v189
    v_mul_f32 v190, v94, v190
    v_mul_f32 v191, v95, v191
    s_setprio 2
    s_waitcnt lgkmcnt(0)
    v_cvt_pk_bf16_f32 v172, v72, v73
    v_cvt_pk_bf16_f32 v173, v74, v75
    v_cvt_pk_bf16_f32 v174, v76, v77
    v_cvt_pk_bf16_f32 v175, v78, v79
    v_rcp_f32 v176, v176
    v_rcp_f32 v177, v177
    v_mfma_f32_32x32x16_bf16 v[16:31], v[120:123], v[172:175], v[16:31]
    v_rcp_f32 v178, v178
    v_rcp_f32 v179, v179
    v_rcp_f32 v180, v180
    v_mfma_f32_32x32x16_bf16 v[32:47], v[124:127], v[172:175], v[32:47]
    v_rcp_f32 v181, v181
    v_rcp_f32 v182, v182
    v_rcp_f32 v183, v183
    v_mfma_f32_32x32x16_bf16 v[48:63], v[128:131], v[172:175], v[48:63]
    v_exp_f32 v184, v184
    v_exp_f32 v185, v185
    v_exp_f32 v186, v186
    v_exp_f32 v187, v187
    v_exp_f32 v188, v188
    v_exp_f32 v189, v189
    v_exp_f32 v190, v190
    v_exp_f32 v191, v191
    s_setprio 0
    ds_read_b64_tr_b16 v[156:157], v5 offset:43008
    ds_read_b64_tr_b16 v[158:159], v5 offset:44544
    ds_read_b64_tr_b16 v[160:161], v5 offset:43072
    ds_read_b64_tr_b16 v[162:163], v5 offset:44608
    ds_read_b64_tr_b16 v[164:165], v5 offset:43136
    ds_read_b64_tr_b16 v[166:167], v5 offset:44672
    ds_read_b128 v[232:235], v13 offset:2048
    ds_read_b128 v[236:239], v13 offset:2064
    ds_read_b128 v[144:147], v13 offset:2112
    ds_read_b128 v[148:151], v13 offset:2128
    ds_read_b128 v[248:251], v13 offset:2240
    ds_read_b128 v[252:255], v13 offset:2256
    v_add_f32 v184, 1.0, v184
    v_add_f32 v185, 1.0, v185
    v_add_f32 v186, 1.0, v186
    v_add_f32 v187, 1.0, v187
    v_add_f32 v188, 1.0, v188
    v_add_f32 v189, 1.0, v189
    v_add_f32 v190, 1.0, v190
    v_add_f32 v191, 1.0, v191
    v_mul_f32 v80, v80, v176
    v_mul_f32 v81, v81, v177
    v_mul_f32 v82, v82, v178
    v_mul_f32 v83, v83, v179
    v_mul_f32 v84, v84, v180
    v_mul_f32 v85, v85, v181
    v_mul_f32 v86, v86, v182
    v_mul_f32 v87, v87, v183
    v_and_b32 v193, 0xffff0000, v208
    v_and_b32 v195, 0xffff0000, v209
    v_and_b32 v197, 0xffff0000, v210
    v_and_b32 v199, 0xffff0000, v211
    v_and_b32 v201, 0xffff0000, v212
    v_and_b32 v203, 0xffff0000, v213
    v_and_b32 v205, 0xffff0000, v214
    v_and_b32 v207, 0xffff0000, v215
    v_and_b32 v97, 0xffff0000, v216
    v_and_b32 v99, 0xffff0000, v217
    v_and_b32 v101, 0xffff0000, v218
    v_and_b32 v103, 0xffff0000, v219
    v_and_b32 v105, 0xffff0000, v220
    v_and_b32 v107, 0xffff0000, v221
    v_and_b32 v109, 0xffff0000, v222
    v_and_b32 v111, 0xffff0000, v223
    s_setprio 2
    s_waitcnt lgkmcnt(0)
    v_cvt_pk_bf16_f32 v168, v80, v81
    v_cvt_pk_bf16_f32 v169, v82, v83
    v_cvt_pk_bf16_f32 v170, v84, v85
    v_cvt_pk_bf16_f32 v171, v86, v87
    v_rcp_f32 v184, v184
    v_rcp_f32 v185, v185
    v_mfma_f32_32x32x16_bf16 v[16:31], v[156:159], v[168:171], v[16:31]
    v_rcp_f32 v186, v186
    v_rcp_f32 v187, v187
    v_rcp_f32 v188, v188
    v_mfma_f32_32x32x16_bf16 v[32:47], v[160:163], v[168:171], v[32:47]
    v_rcp_f32 v189, v189
    v_rcp_f32 v190, v190
    v_rcp_f32 v191, v191
    v_mfma_f32_32x32x16_bf16 v[48:63], v[164:167], v[168:171], v[48:63]
    s_setprio 0
    ds_read_b64_tr_b16 v[132:133], v5 offset:46080
    ds_read_b64_tr_b16 v[134:135], v5 offset:47616
    ds_read_b64_tr_b16 v[136:137], v5 offset:46144
    ds_read_b64_tr_b16 v[138:139], v5 offset:47680
    ds_read_b64_tr_b16 v[140:141], v5 offset:46208
    ds_read_b64_tr_b16 v[142:143], v5 offset:47744
    ds_read_b128 v[64:67], v13 offset:1920
    ds_read_b128 v[68:71], v13 offset:1936
    ds_read_b128 v[72:75], v13 offset:1984
    ds_read_b128 v[76:79], v13 offset:2000
    ds_read_b128 v[176:179], v13 offset:2176
    ds_read_b128 v[180:183], v13 offset:2192
    ds_read_u8 v0, v15 offset:11
    v_mul_f32 v88, v88, v184
    v_mul_f32 v89, v89, v185
    v_mul_f32 v90, v90, v186
    v_mul_f32 v91, v91, v187
    v_mul_f32 v92, v92, v188
    v_mul_f32 v93, v93, v189
    v_mul_f32 v94, v94, v190
    v_mul_f32 v95, v95, v191
    v_and_b32 v113, 0xffff0000, v224
    v_and_b32 v115, 0xffff0000, v225
    v_and_b32 v117, 0xffff0000, v226
    v_and_b32 v119, 0xffff0000, v227
    v_and_b32 v241, 0xffff0000, v228
    v_and_b32 v243, 0xffff0000, v229
    v_and_b32 v245, 0xffff0000, v230
    v_and_b32 v247, 0xffff0000, v231
    v_xor_b32 v7, 32, v8
    s_setprio 2
    s_waitcnt lgkmcnt(0)
    v_cvt_pk_bf16_f32 v172, v88, v89
    v_cvt_pk_bf16_f32 v173, v90, v91
    v_cvt_pk_bf16_f32 v174, v92, v93
    v_cvt_pk_bf16_f32 v175, v94, v95
    v_lshlrev_b32 v192, 16, v208
    v_lshlrev_b32 v194, 16, v209
    v_mfma_f32_32x32x16_bf16 v[16:31], v[132:135], v[172:175], v[16:31]
    v_lshlrev_b32 v196, 16, v210
    v_lshlrev_b32 v198, 16, v211
    v_lshlrev_b32 v200, 16, v212
    v_lshlrev_b32 v202, 16, v213
    v_lshlrev_b32 v204, 16, v214
    v_lshlrev_b32 v206, 16, v215
    v_mfma_f32_32x32x16_bf16 v[32:47], v[136:139], v[172:175], v[32:47]
    v_lshlrev_b32 v96, 16, v216
    v_lshlrev_b32 v98, 16, v217
    v_lshlrev_b32 v100, 16, v218
    v_lshlrev_b32 v102, 16, v219
    v_lshlrev_b32 v104, 16, v220
    v_lshlrev_b32 v106, 16, v221
    v_mfma_f32_32x32x16_bf16 v[48:63], v[140:143], v[172:175], v[48:63]
    v_lshlrev_b32 v108, 16, v222
    v_lshlrev_b32 v110, 16, v223
    v_lshlrev_b32 v112, 16, v224
    v_lshlrev_b32 v114, 16, v225
    v_lshlrev_b32 v116, 16, v226
    v_lshlrev_b32 v118, 16, v227
    v_lshlrev_b32 v240, 16, v228
    v_lshlrev_b32 v242, 16, v229
    v_lshlrev_b32 v244, 16, v230
    v_lshlrev_b32 v246, 16, v231
    v_add_u32 v9, s10, v9
    v_pk_fma_f32 v[192:193], v[16:17], v[64:65], v[192:193]
    v_pk_fma_f32 v[194:195], v[18:19], v[66:67], v[194:195]
    v_pk_fma_f32 v[196:197], v[20:21], v[68:69], v[196:197]
    v_pk_fma_f32 v[198:199], v[22:23], v[70:71], v[198:199]
    v_pk_fma_f32 v[200:201], v[24:25], v[72:73], v[200:201]
    v_pk_fma_f32 v[202:203], v[26:27], v[74:75], v[202:203]
    v_pk_fma_f32 v[204:205], v[28:29], v[76:77], v[204:205]
    v_pk_fma_f32 v[206:207], v[30:31], v[78:79], v[206:207]
    v_pk_fma_f32 v[96:97], v[32:33], v[232:233], v[96:97]
    v_pk_fma_f32 v[98:99], v[34:35], v[234:235], v[98:99]
    v_pk_fma_f32 v[100:101], v[36:37], v[236:237], v[100:101]
    v_pk_fma_f32 v[102:103], v[38:39], v[238:239], v[102:103]
    v_pk_fma_f32 v[104:105], v[40:41], v[144:145], v[104:105]
    v_pk_fma_f32 v[106:107], v[42:43], v[146:147], v[106:107]
    v_pk_fma_f32 v[108:109], v[44:45], v[148:149], v[108:109]
    v_pk_fma_f32 v[110:111], v[46:47], v[150:151], v[110:111]
    v_pk_fma_f32 v[112:113], v[48:49], v[176:177], v[112:113]
    v_pk_fma_f32 v[114:115], v[50:51], v[178:179], v[114:115]
    v_pk_fma_f32 v[116:117], v[52:53], v[180:181], v[116:117]
    v_pk_fma_f32 v[118:119], v[54:55], v[182:183], v[118:119]
    v_pk_fma_f32 v[240:241], v[56:57], v[248:249], v[240:241]
    v_pk_fma_f32 v[242:243], v[58:59], v[250:251], v[242:243]
    v_pk_fma_f32 v[244:245], v[60:61], v[252:253], v[244:245]
    v_pk_fma_f32 v[246:247], v[62:63], v[254:255], v[246:247]
    v_readfirstlane_b32 s54, v0
    s_nop 0
    s_cmp_gt_u32 s54, s49
    s_cbranch_scc1 L_part_ok
L_part:
    ds_read_u8 v0, v15 offset:11
    s_waitcnt lgkmcnt(0)
    v_readfirstlane_b32 s54, v0
    s_nop 0
    s_cmp_gt_u32 s54, s49
    s_cbranch_scc0 L_part
L_part_ok:
    ds_read_b128 v[16:19], v9 offset:0
    ds_read_b128 v[20:23], v9 offset:1024
    ds_read_b128 v[24:27], v9 offset:2048
    ds_read_b128 v[28:31], v9 offset:3072
    ds_read_b128 v[32:35], v9 offset:4096
    ds_read_b128 v[36:39], v9 offset:5120
    ds_read_b128 v[40:43], v9 offset:6144
    ds_read_b128 v[44:47], v9 offset:7168
    ds_read_b128 v[48:51], v9 offset:8192
    ds_read_b128 v[52:55], v9 offset:9216
    ds_read_b128 v[56:59], v9 offset:10240
    ds_read_b128 v[60:63], v9 offset:11264
    s_waitcnt lgkmcnt(10)
    v_pk_fma_f32 v[192:193], v[16:17], v[64:65], v[192:193]
    v_pk_fma_f32 v[194:195], v[18:19], v[66:67], v[194:195]
    v_pk_fma_f32 v[196:197], v[20:21], v[68:69], v[196:197]
    v_pk_fma_f32 v[198:199], v[22:23], v[70:71], v[198:199]
    v_cvt_pk_bf16_f32 v208, v192, v193
    v_cvt_pk_bf16_f32 v209, v194, v195
    v_cvt_pk_bf16_f32 v210, v196, v197
    v_cvt_pk_bf16_f32 v211, v198, v199
    ds_write_b128 v8, v[208:211] offset:0
    s_waitcnt lgkmcnt(9)
    v_pk_fma_f32 v[200:201], v[24:25], v[72:73], v[200:201]
    v_pk_fma_f32 v[202:203], v[26:27], v[74:75], v[202:203]
    v_pk_fma_f32 v[204:205], v[28:29], v[76:77], v[204:205]
    v_pk_fma_f32 v[206:207], v[30:31], v[78:79], v[206:207]
    v_cvt_pk_bf16_f32 v212, v200, v201
    v_cvt_pk_bf16_f32 v213, v202, v203
    v_cvt_pk_bf16_f32 v214, v204, v205
    v_cvt_pk_bf16_f32 v215, v206, v207
    ds_write_b128 v7, v[212:215] offset:0
    s_waitcnt lgkmcnt(8)
    v_pk_fma_f32 v[96:97], v[32:33], v[232:233], v[96:97]
    v_pk_fma_f32 v[98:99], v[34:35], v[234:235], v[98:99]
    v_pk_fma_f32 v[100:101], v[36:37], v[236:237], v[100:101]
    v_pk_fma_f32 v[102:103], v[38:39], v[238:239], v[102:103]
    v_cvt_pk_bf16_f32 v216, v96, v97
    v_cvt_pk_bf16_f32 v217, v98, v99
    v_cvt_pk_bf16_f32 v218, v100, v101
    v_cvt_pk_bf16_f32 v219, v102, v103
    ds_write_b128 v8, v[216:219] offset:64
    s_waitcnt lgkmcnt(7)
    v_pk_fma_f32 v[104:105], v[40:41], v[144:145], v[104:105]
    v_pk_fma_f32 v[106:107], v[42:43], v[146:147], v[106:107]
    v_pk_fma_f32 v[108:109], v[44:45], v[148:149], v[108:109]
    v_pk_fma_f32 v[110:111], v[46:47], v[150:151], v[110:111]
    v_cvt_pk_bf16_f32 v220, v104, v105
    v_cvt_pk_bf16_f32 v221, v106, v107
    v_cvt_pk_bf16_f32 v222, v108, v109
    v_cvt_pk_bf16_f32 v223, v110, v111
    ds_write_b128 v7, v[220:223] offset:64
    s_waitcnt lgkmcnt(6)
    v_pk_fma_f32 v[112:113], v[48:49], v[176:177], v[112:113]
    v_pk_fma_f32 v[114:115], v[50:51], v[178:179], v[114:115]
    v_pk_fma_f32 v[116:117], v[52:53], v[180:181], v[116:117]
    v_pk_fma_f32 v[118:119], v[54:55], v[182:183], v[118:119]
    v_cvt_pk_bf16_f32 v224, v112, v113
    v_cvt_pk_bf16_f32 v225, v114, v115
    v_cvt_pk_bf16_f32 v226, v116, v117
    v_cvt_pk_bf16_f32 v227, v118, v119
    ds_write_b128 v8, v[224:227] offset:128
    s_waitcnt lgkmcnt(5)
    v_pk_fma_f32 v[240:241], v[56:57], v[248:249], v[240:241]
    v_pk_fma_f32 v[242:243], v[58:59], v[250:251], v[242:243]
    v_pk_fma_f32 v[244:245], v[60:61], v[252:253], v[244:245]
    v_pk_fma_f32 v[246:247], v[62:63], v[254:255], v[246:247]
    v_cvt_pk_bf16_f32 v228, v240, v241
    v_cvt_pk_bf16_f32 v229, v242, v243
    v_cvt_pk_bf16_f32 v230, v244, v245
    v_cvt_pk_bf16_f32 v231, v246, v247
    ds_write_b128 v7, v[228:231] offset:128
    s_add_u32 s54, s57, s59
    ds_read_b128 v[64:67], v9 offset:0
    ds_read_b128 v[68:71], v9 offset:1024
    ds_read_b128 v[72:75], v9 offset:2048
    ds_read_b128 v[76:79], v9 offset:3072
    ds_read_b128 v[80:83], v9 offset:4096
    ds_read_b128 v[84:87], v9 offset:5120
    s_waitcnt lgkmcnt(5)
    buffer_store_dwordx4 v[64:67], v10, s[40:43], s57 offen sc1
    s_waitcnt lgkmcnt(4)
    buffer_store_dwordx4 v[68:71], v11, s[40:43], s57 offen sc1
    s_waitcnt lgkmcnt(3)
    buffer_store_dwordx4 v[72:75], v12, s[40:43], s57 offen sc1
    s_waitcnt lgkmcnt(2)
    buffer_store_dwordx4 v[76:79], v10, s[40:43], s54 offen sc1
    s_waitcnt lgkmcnt(1)
    buffer_store_dwordx4 v[80:83], v11, s[40:43], s54 offen sc1
    s_waitcnt lgkmcnt(0)
    buffer_store_dwordx4 v[84:87], v12, s[40:43], s54 offen sc1
    s_endpgm
L_helper:
    v_mov_b32 v3, 9
    ds_read_b64 v[96:97], v245 offset:0
    ds_read_b64 v[98:99], v245 offset:512
    ds_read_b64 v[100:101], v245 offset:1024
    ds_read_b64 v[102:103], v245 offset:1536
    ds_read_b64 v[104:105], v245 offset:2048
    ds_read_b64 v[106:107], v245 offset:2560
    ds_read_b64 v[108:109], v245 offset:3072
    ds_read_b64 v[110:111], v245 offset:3584
    ds_read_b64 v[112:113], v245 offset:4096
    ds_read_b64 v[114:115], v245 offset:4608
    ds_read_b64 v[116:117], v245 offset:5120
    ds_read_b64 v[118:119], v245 offset:5632
    s_waitcnt lgkmcnt(10)
    v_mfma_f32_32x32x16_bf16 v[16:31], v[248:251], v[96:99], 0
    s_waitcnt lgkmcnt(8)
    v_mfma_f32_32x32x16_bf16 v[16:31], v[252:255], v[100:103], v[16:31]
    s_waitcnt lgkmcnt(4)
    ds_read_b128 v[192:195], v6 offset:0
    ds_read_b128 v[196:199], v6 offset:32
    ds_read_b128 v[200:203], v6 offset:64
    ds_read_b128 v[204:207], v6 offset:96
    v_mfma_f32_32x32x16_bf16 v[32:47], v[248:251], v[104:107], 0
    ds_read_b64_tr_b16 v[120:121], v4 offset:0
    ds_read_b64_tr_b16 v[122:123], v4 offset:1024
    ds_read_b64_tr_b16 v[124:125], v4 offset:2048
    ds_read_b64_tr_b16 v[126:127], v4 offset:3072
    v_mfma_f32_32x32x16_bf16 v[32:47], v[252:255], v[108:111], v[32:47]
    s_waitcnt lgkmcnt(8)
    ds_write_b8 v14, v3
    ds_read_b64_tr_b16 v[128:129], v4 offset:4096
    ds_read_b64_tr_b16 v[130:131], v4 offset:5120
    ds_read_b64_tr_b16 v[132:133], v4 offset:6144
    v_mfma_f32_32x32x16_bf16 v[48:63], v[248:251], v[112:115], 0
    ds_read_b64_tr_b16 v[134:135], v4 offset:7168
    ds_read_b64_tr_b16 v[136:137], v4 offset:8192
    ds_read_b64_tr_b16 v[138:139], v4 offset:9216
    ds_read_b64_tr_b16 v[140:141], v4 offset:10240
    ds_read_b64_tr_b16 v[142:143], v4 offset:11264
    v_mfma_f32_32x32x16_bf16 v[48:63], v[252:255], v[116:119], v[48:63]
    v_mul_f32 v238, v16, v16
    v_mul_f32 v239, v17, v17
    v_fmac_f32 v238, v18, v18
    v_fmac_f32 v239, v19, v19
    v_fmac_f32 v238, v20, v20
    v_fmac_f32 v239, v21, v21
    v_mfma_f32_32x32x16_bf16 v[176:191], v[80:83], v[96:99], 0
    v_fmac_f32 v238, v22, v22
    v_fmac_f32 v239, v23, v23
    v_fmac_f32 v238, v24, v24
    v_fmac_f32 v239, v25, v25
    v_fmac_f32 v238, v26, v26
    v_fmac_f32 v239, v27, v27
    v_mfma_f32_32x32x16_bf16 v[176:191], v[80:83], v[100:103], v[176:191]
    v_fmac_f32 v238, v28, v28
    v_fmac_f32 v239, v29, v29
    v_fmac_f32 v238, v30, v30
    v_fmac_f32 v239, v31, v31
    v_fmac_f32 v238, v32, v32
    v_fmac_f32 v239, v33, v33
    v_mfma_f32_32x32x16_bf16 v[176:191], v[80:83], v[104:107], v[176:191]
    v_fmac_f32 v238, v34, v34
    v_fmac_f32 v239, v35, v35
    v_fmac_f32 v238, v36, v36
    v_fmac_f32 v239, v37, v37
    v_fmac_f32 v238, v38, v38
    v_fmac_f32 v239, v39, v39
    v_mfma_f32_32x32x16_bf16 v[176:191], v[80:83], v[108:111], v[176:191]
    v_fmac_f32 v238, v40, v40
    v_fmac_f32 v239, v41, v41
    v_fmac_f32 v238, v42, v42
    v_fmac_f32 v239, v43, v43
    v_fmac_f32 v238, v44, v44
    v_fmac_f32 v239, v45, v45
    v_mfma_f32_32x32x16_bf16 v[176:191], v[80:83], v[112:115], v[176:191]
    v_fmac_f32 v238, v46, v46
    v_fmac_f32 v239, v47, v47
    v_fmac_f32 v238, v48, v48
    v_fmac_f32 v239, v49, v49
    v_fmac_f32 v238, v50, v50
    v_fmac_f32 v239, v51, v51
    v_mfma_f32_32x32x16_bf16 v[176:191], v[80:83], v[116:119], v[176:191]
    v_fmac_f32 v238, v52, v52
    v_fmac_f32 v239, v53, v53
    v_fmac_f32 v238, v54, v54
    v_fmac_f32 v239, v55, v55
    v_fmac_f32 v238, v56, v56
    v_fmac_f32 v239, v57, v57
    v_fmac_f32 v238, v58, v58
    v_fmac_f32 v239, v59, v59
    v_fmac_f32 v238, v60, v60
    v_fmac_f32 v239, v61, v61
    v_fmac_f32 v238, v62, v62
    v_fmac_f32 v239, v63, v63
    v_add_f32 v238, v238, v239
    v_mov_b32 v239, v238
    v_mul_f32 v176, 0x3c2aaaab, v176
    s_nop 0
    v_permlane32_swap_b32 v238, v239
    v_add_f32 v238, v238, v239
    v_fmamk_f32 v238, v238, 0x3c2aaaab, v233
    v_fma_f32 v238, -v176, v176, v238
    v_max_f32 v238, v233, v238
    v_rsq_f32 v233, v238
    s_waitcnt lgkmcnt(0)
    v_mul_f32 v232, 0xbeeff558, v233
    v_mul_f32 v233, 0xbeeff558, v233
    v_mul_f32 v234, v176, v232
    v_mul_f32 v235, v176, v232
    v_pk_fma_f32 v[16:17], v[16:17], v[232:233], v[234:235]
    v_pk_fma_f32 v[18:19], v[18:19], v[232:233], v[234:235]
    v_pk_fma_f32 v[20:21], v[20:21], v[232:233], v[234:235]
    v_pk_fma_f32 v[22:23], v[22:23], v[232:233], v[234:235]
    v_pk_fma_f32 v[24:25], v[24:25], v[232:233], v[234:235]
    v_pk_fma_f32 v[26:27], v[26:27], v[232:233], v[234:235]
    v_pk_fma_f32 v[28:29], v[28:29], v[232:233], v[234:235]
    v_pk_fma_f32 v[30:31], v[30:31], v[232:233], v[234:235]
    v_pk_fma_f32 v[32:33], v[32:33], v[232:233], v[234:235]
    v_pk_fma_f32 v[34:35], v[34:35], v[232:233], v[234:235]
    v_pk_fma_f32 v[36:37], v[36:37], v[232:233], v[234:235]
    v_pk_fma_f32 v[38:39], v[38:39], v[232:233], v[234:235]
    v_pk_fma_f32 v[40:41], v[40:41], v[232:233], v[234:235]
    v_pk_fma_f32 v[42:43], v[42:43], v[232:233], v[234:235]
    v_pk_fma_f32 v[44:45], v[44:45], v[232:233], v[234:235]
    v_pk_fma_f32 v[46:47], v[46:47], v[232:233], v[234:235]
    v_pk_fma_f32 v[48:49], v[48:49], v[232:233], v[234:235]
    v_pk_fma_f32 v[50:51], v[50:51], v[232:233], v[234:235]
    v_pk_fma_f32 v[52:53], v[52:53], v[232:233], v[234:235]
    v_pk_fma_f32 v[54:55], v[54:55], v[232:233], v[234:235]
    v_pk_fma_f32 v[56:57], v[56:57], v[232:233], v[234:235]
    v_pk_fma_f32 v[58:59], v[58:59], v[232:233], v[234:235]
    v_pk_fma_f32 v[60:61], v[60:61], v[232:233], v[234:235]
    v_pk_fma_f32 v[62:63], v[62:63], v[232:233], v[234:235]
    v_cvt_pk_bf16_f32 v96, v16, v17
    v_cvt_pk_bf16_f32 v97, v18, v19
    v_cvt_pk_bf16_f32 v98, v20, v21
    v_cvt_pk_bf16_f32 v99, v22, v23
    v_cvt_pk_bf16_f32 v100, v24, v25
    v_cvt_pk_bf16_f32 v101, v26, v27
    v_mfma_f32_32x32x16_bf16 v[80:95], v[120:123], v[96:99], v[192:207]
    v_cvt_pk_bf16_f32 v102, v28, v29
    v_cvt_pk_bf16_f32 v103, v30, v31
    v_cvt_pk_bf16_f32 v104, v32, v33
    v_cvt_pk_bf16_f32 v105, v34, v35
    v_mfma_f32_32x32x16_bf16 v[80:95], v[124:127], v[100:103], v[80:95]
    v_cvt_pk_bf16_f32 v106, v36, v37
    v_cvt_pk_bf16_f32 v107, v38, v39
    v_cvt_pk_bf16_f32 v108, v40, v41
    v_cvt_pk_bf16_f32 v109, v42, v43
    v_mfma_f32_32x32x16_bf16 v[80:95], v[128:131], v[104:107], v[80:95]
    v_cvt_pk_bf16_f32 v110, v44, v45
    v_cvt_pk_bf16_f32 v111, v46, v47
    v_cvt_pk_bf16_f32 v112, v48, v49
    v_cvt_pk_bf16_f32 v113, v50, v51
    v_mfma_f32_32x32x16_bf16 v[80:95], v[132:135], v[108:111], v[80:95]
    v_cvt_pk_bf16_f32 v114, v52, v53
    v_cvt_pk_bf16_f32 v115, v54, v55
    v_cvt_pk_bf16_f32 v116, v56, v57
    v_cvt_pk_bf16_f32 v117, v58, v59
    v_mfma_f32_32x32x16_bf16 v[80:95], v[136:139], v[112:115], v[80:95]
    v_cvt_pk_bf16_f32 v118, v60, v61
    v_cvt_pk_bf16_f32 v119, v62, v63
    v_mov_b32 v1, 1
    v_add_u32 v7, 147456, v9
    v_mfma_f32_32x32x16_bf16 v[80:95], v[140:143], v[116:119], v[80:95]
    s_setprio 0
    s_nop 10
    v_fmaak_f32 v176, v80, v80, 0x409d30fc
    v_fmaak_f32 v177, v81, v81, 0x409d30fc
    v_fmaak_f32 v178, v82, v82, 0x409d30fc
    v_fmaak_f32 v179, v83, v83, 0x409d30fc
    v_fmaak_f32 v180, v84, v84, 0x409d30fc
    v_fmaak_f32 v181, v85, v85, 0x409d30fc
    v_fmaak_f32 v182, v86, v86, 0x409d30fc
    v_fmaak_f32 v183, v87, v87, 0x409d30fc
    v_mul_f32 v176, v80, v176
    v_mul_f32 v177, v81, v177
    v_mul_f32 v178, v82, v178
    v_mul_f32 v179, v83, v179
    v_mul_f32 v180, v84, v180
    v_mul_f32 v181, v85, v181
    v_mul_f32 v182, v86, v182
    v_mul_f32 v183, v87, v183
    s_setprio 2
    s_waitcnt lgkmcnt(0)
    v_exp_f32 v176, v176
    v_exp_f32 v177, v177
    v_exp_f32 v178, v178
    v_exp_f32 v179, v179
    v_exp_f32 v180, v180
    v_exp_f32 v181, v181
    v_exp_f32 v182, v182
    v_exp_f32 v183, v183
    s_setprio 0
    ds_read_b128 v[192:195], v6 offset:128
    ds_read_b128 v[196:199], v6 offset:160
    ds_read_b128 v[200:203], v6 offset:192
    ds_read_b128 v[204:207], v6 offset:224
    ds_read_b64_tr_b16 v[120:121], v4 offset:512
    ds_read_b64_tr_b16 v[122:123], v4 offset:1536
    ds_read_b64_tr_b16 v[124:125], v4 offset:2560
    ds_read_b64_tr_b16 v[126:127], v4 offset:3584
    ds_read_b64_tr_b16 v[128:129], v4 offset:4608
    ds_read_b64_tr_b16 v[130:131], v4 offset:5632
    ds_read_b64_tr_b16 v[132:133], v4 offset:6656
    ds_read_b64_tr_b16 v[134:135], v4 offset:7680
    ds_read_b64_tr_b16 v[136:137], v4 offset:8704
    ds_read_b64_tr_b16 v[138:139], v4 offset:9728
    ds_read_b64_tr_b16 v[140:141], v4 offset:10752
    ds_read_b64_tr_b16 v[142:143], v4 offset:11776
    v_add_f32 v176, 1.0, v176
    v_add_f32 v177, 1.0, v177
    v_add_f32 v178, 1.0, v178
    v_add_f32 v179, 1.0, v179
    v_add_f32 v180, 1.0, v180
    v_add_f32 v181, 1.0, v181
    v_add_f32 v182, 1.0, v182
    v_add_f32 v183, 1.0, v183
    v_fmaak_f32 v184, v88, v88, 0x409d30fc
    v_fmaak_f32 v185, v89, v89, 0x409d30fc
    v_fmaak_f32 v186, v90, v90, 0x409d30fc
    v_fmaak_f32 v187, v91, v91, 0x409d30fc
    v_fmaak_f32 v188, v92, v92, 0x409d30fc
    v_fmaak_f32 v189, v93, v93, 0x409d30fc
    v_fmaak_f32 v190, v94, v94, 0x409d30fc
    v_fmaak_f32 v191, v95, v95, 0x409d30fc
    v_mul_f32 v184, v88, v184
    v_mul_f32 v185, v89, v185
    v_mul_f32 v186, v90, v186
    v_mul_f32 v187, v91, v187
    v_mul_f32 v188, v92, v188
    v_mul_f32 v189, v93, v189
    v_mul_f32 v190, v94, v190
    v_mul_f32 v191, v95, v191
    s_setprio 2
    s_waitcnt lgkmcnt(0)
    v_mfma_f32_32x32x16_bf16 v[64:79], v[120:123], v[96:99], v[192:207]
    v_rcp_f32 v176, v176
    v_rcp_f32 v177, v177
    v_rcp_f32 v178, v178
    v_mfma_f32_32x32x16_bf16 v[64:79], v[124:127], v[100:103], v[64:79]
    v_rcp_f32 v179, v179
    v_rcp_f32 v180, v180
    v_rcp_f32 v181, v181
    v_mfma_f32_32x32x16_bf16 v[64:79], v[128:131], v[104:107], v[64:79]
    v_rcp_f32 v182, v182
    v_rcp_f32 v183, v183
    v_exp_f32 v184, v184
    v_mfma_f32_32x32x16_bf16 v[64:79], v[132:135], v[108:111], v[64:79]
    v_exp_f32 v185, v185
    v_exp_f32 v186, v186
    v_exp_f32 v187, v187
    v_mfma_f32_32x32x16_bf16 v[64:79], v[136:139], v[112:115], v[64:79]
    v_exp_f32 v188, v188
    v_exp_f32 v189, v189
    v_exp_f32 v190, v190
    v_mfma_f32_32x32x16_bf16 v[64:79], v[140:143], v[116:119], v[64:79]
    v_exp_f32 v191, v191
    s_setprio 0
    ds_read_b64_tr_b16 v[156:157], v5 offset:12288
    ds_read_b64_tr_b16 v[158:159], v5 offset:13824
    ds_read_b64_tr_b16 v[160:161], v5 offset:12352
    ds_read_b64_tr_b16 v[162:163], v5 offset:13888
    ds_read_b64_tr_b16 v[164:165], v5 offset:12416
    ds_read_b64_tr_b16 v[166:167], v5 offset:13952
    v_add_f32 v184, 1.0, v184
    v_add_f32 v185, 1.0, v185
    v_add_f32 v186, 1.0, v186
    v_add_f32 v187, 1.0, v187
    v_add_f32 v188, 1.0, v188
    v_add_f32 v189, 1.0, v189
    v_add_f32 v190, 1.0, v190
    v_add_f32 v191, 1.0, v191
    v_mul_f32 v80, v80, v176
    v_mul_f32 v81, v81, v177
    v_mul_f32 v82, v82, v178
    v_mul_f32 v83, v83, v179
    v_mul_f32 v84, v84, v180
    v_mul_f32 v85, v85, v181
    v_mul_f32 v86, v86, v182
    v_mul_f32 v87, v87, v183
    v_fmaak_f32 v176, v64, v64, 0x409d30fc
    v_fmaak_f32 v177, v65, v65, 0x409d30fc
    v_fmaak_f32 v178, v66, v66, 0x409d30fc
    v_fmaak_f32 v179, v67, v67, 0x409d30fc
    v_fmaak_f32 v180, v68, v68, 0x409d30fc
    v_fmaak_f32 v181, v69, v69, 0x409d30fc
    v_fmaak_f32 v182, v70, v70, 0x409d30fc
    v_fmaak_f32 v183, v71, v71, 0x409d30fc
    v_mul_f32 v176, v64, v176
    v_mul_f32 v177, v65, v177
    v_mul_f32 v178, v66, v178
    v_mul_f32 v179, v67, v179
    v_mul_f32 v180, v68, v180
    v_mul_f32 v181, v69, v181
    v_mul_f32 v182, v70, v182
    v_mul_f32 v183, v71, v183
    s_setprio 2
    s_waitcnt lgkmcnt(0)
    v_cvt_pk_bf16_f32 v168, v80, v81
    v_cvt_pk_bf16_f32 v169, v82, v83
    v_cvt_pk_bf16_f32 v170, v84, v85
    v_cvt_pk_bf16_f32 v171, v86, v87
    v_rcp_f32 v184, v184
    v_rcp_f32 v185, v185
    v_mfma_f32_32x32x16_bf16 v[16:31], v[156:159], v[168:171], 0
    v_rcp_f32 v186, v186
    v_rcp_f32 v187, v187
    v_rcp_f32 v188, v188
    v_mfma_f32_32x32x16_bf16 v[32:47], v[160:163], v[168:171], 0
    v_rcp_f32 v189, v189
    v_rcp_f32 v190, v190
    v_rcp_f32 v191, v191
    v_mfma_f32_32x32x16_bf16 v[48:63], v[164:167], v[168:171], 0
    v_exp_f32 v176, v176
    v_exp_f32 v177, v177
    v_exp_f32 v178, v178
    v_exp_f32 v179, v179
    v_exp_f32 v180, v180
    v_exp_f32 v181, v181
    v_exp_f32 v182, v182
    v_exp_f32 v183, v183
    s_setprio 0
    ds_read_b128 v[192:195], v6 offset:256
    ds_read_b128 v[196:199], v6 offset:288
    ds_read_b128 v[200:203], v6 offset:320
    ds_read_b128 v[204:207], v6 offset:352
    ds_read_b64_tr_b16 v[120:121], v4 offset:24576
    ds_read_b64_tr_b16 v[122:123], v4 offset:25600
    ds_read_b64_tr_b16 v[124:125], v4 offset:26624
    ds_read_b64_tr_b16 v[126:127], v4 offset:27648
    ds_read_b64_tr_b16 v[128:129], v4 offset:28672
    ds_read_b64_tr_b16 v[130:131], v4 offset:29696
    ds_read_b64_tr_b16 v[132:133], v4 offset:30720
    ds_read_b64_tr_b16 v[134:135], v4 offset:31744
    ds_read_b64_tr_b16 v[136:137], v4 offset:32768
    ds_read_b64_tr_b16 v[138:139], v4 offset:33792
    ds_read_b64_tr_b16 v[140:141], v4 offset:34816
    ds_read_b64_tr_b16 v[142:143], v4 offset:35840
    ds_read_b32 v0, v15 offset:8
    v_add_f32 v176, 1.0, v176
    v_add_f32 v177, 1.0, v177
    v_add_f32 v178, 1.0, v178
    v_add_f32 v179, 1.0, v179
    v_add_f32 v180, 1.0, v180
    v_add_f32 v181, 1.0, v181
    v_add_f32 v182, 1.0, v182
    v_add_f32 v183, 1.0, v183
    v_mul_f32 v1, v88, v184
    v_mul_f32 v2, v89, v185
    v_mul_f32 v3, v90, v186
    v_mul_f32 v10, v91, v187
    v_mul_f32 v11, v92, v188
    v_mul_f32 v12, v93, v189
    v_mul_f32 v13, v94, v190
    v_mul_f32 v14, v95, v191
    v_fmaak_f32 v184, v72, v72, 0x409d30fc
    v_fmaak_f32 v185, v73, v73, 0x409d30fc
    v_fmaak_f32 v186, v74, v74, 0x409d30fc
    v_fmaak_f32 v187, v75, v75, 0x409d30fc
    v_fmaak_f32 v188, v76, v76, 0x409d30fc
    v_fmaak_f32 v189, v77, v77, 0x409d30fc
    v_fmaak_f32 v190, v78, v78, 0x409d30fc
    v_fmaak_f32 v191, v79, v79, 0x409d30fc
    v_mul_f32 v184, v72, v184
    v_mul_f32 v185, v73, v185
    v_mul_f32 v186, v74, v186
    v_mul_f32 v187, v75, v187
    v_mul_f32 v188, v76, v188
    v_mul_f32 v189, v77, v189
    v_mul_f32 v190, v78, v190
    v_mul_f32 v191, v79, v191
    s_setprio 2
    s_waitcnt lgkmcnt(0)
    v_mfma_f32_32x32x16_bf16 v[80:95], v[120:123], v[96:99], v[192:207]
    v_cvt_pk_bf16_f32 v172, v1, v2
    v_cvt_pk_bf16_f32 v173, v3, v10
    v_rcp_f32 v176, v176
    v_rcp_f32 v177, v177
    v_mfma_f32_32x32x16_bf16 v[80:95], v[124:127], v[100:103], v[80:95]
    v_cvt_pk_bf16_f32 v174, v11, v12
    v_cvt_pk_bf16_f32 v175, v13, v14
    v_rcp_f32 v178, v178
    v_rcp_f32 v179, v179
    v_mfma_f32_32x32x16_bf16 v[80:95], v[128:131], v[104:107], v[80:95]
    v_rcp_f32 v180, v180
    v_rcp_f32 v181, v181
    v_rcp_f32 v182, v182
    v_mfma_f32_32x32x16_bf16 v[80:95], v[132:135], v[108:111], v[80:95]
    v_rcp_f32 v183, v183
    v_exp_f32 v184, v184
    v_exp_f32 v185, v185
    v_mfma_f32_32x32x16_bf16 v[80:95], v[136:139], v[112:115], v[80:95]
    v_exp_f32 v186, v186
    v_exp_f32 v187, v187
    v_exp_f32 v188, v188
    v_mfma_f32_32x32x16_bf16 v[80:95], v[140:143], v[116:119], v[80:95]
    v_exp_f32 v189, v189
    v_exp_f32 v190, v190
    v_exp_f32 v191, v191
    v_readfirstlane_b32 s54, v0
    s_setprio 0
    s_andn2_b32 s54, 0x010100, s54
    s_cbranch_scc0 L_hand_ok
L_hand:
    ds_read_b32 v0, v15 offset:8
    s_waitcnt lgkmcnt(0)
    v_readfirstlane_b32 s54, v0
    s_nop 0
    s_andn2_b32 s54, 0x010100, s54
    s_cbranch_scc1 L_hand
L_hand_ok:
    ds_read_b64_tr_b16 v[144:145], v5 offset:15360
    ds_read_b64_tr_b16 v[146:147], v5 offset:16896
    ds_read_b64_tr_b16 v[148:149], v5 offset:15424
    ds_read_b64_tr_b16 v[150:151], v5 offset:16960
    ds_read_b64_tr_b16 v[152:153], v5 offset:15488
    ds_read_b64_tr_b16 v[154:155], v5 offset:17024
    ds_read_b64_tr_b16 v[156:157], v5 offset:18432
    ds_read_b64_tr_b16 v[158:159], v5 offset:19968
    ds_read_b64_tr_b16 v[160:161], v5 offset:18496
    ds_read_b64_tr_b16 v[162:163], v5 offset:20032
    ds_read_b64_tr_b16 v[164:165], v5 offset:18560
    ds_read_b64_tr_b16 v[166:167], v5 offset:20096
    ds_read_b128 v[96:99], v7 offset:0
    ds_read_b128 v[100:103], v7 offset:1024
    ds_read_b128 v[104:107], v7 offset:2048
    ds_read_b128 v[108:111], v7 offset:3072
    ds_read_b128 v[112:115], v7 offset:4096
    ds_read_b128 v[116:119], v7 offset:5120
    v_add_f32 v184, 1.0, v184
    v_add_f32 v185, 1.0, v185
    v_add_f32 v186, 1.0, v186
    v_add_f32 v187, 1.0, v187
    v_add_f32 v188, 1.0, v188
    v_add_f32 v189, 1.0, v189
    v_add_f32 v190, 1.0, v190
    v_add_f32 v191, 1.0, v191
    v_mul_f32 v64, v64, v176
    v_mul_f32 v65, v65, v177
    v_mul_f32 v66, v66, v178
    v_mul_f32 v67, v67, v179
    v_mul_f32 v68, v68, v180
    v_mul_f32 v69, v69, v181
    v_mul_f32 v70, v70, v182
    v_mul_f32 v71, v71, v183
    v_fmaak_f32 v176, v80, v80, 0x409d30fc
    v_fmaak_f32 v177, v81, v81, 0x409d30fc
    v_fmaak_f32 v178, v82, v82, 0x409d30fc
    v_fmaak_f32 v179, v83, v83, 0x409d30fc
    v_fmaak_f32 v180, v84, v84, 0x409d30fc
    v_fmaak_f32 v181, v85, v85, 0x409d30fc
    v_fmaak_f32 v182, v86, v86, 0x409d30fc
    v_fmaak_f32 v183, v87, v87, 0x409d30fc
    v_mul_f32 v176, v80, v176
    v_mul_f32 v177, v81, v177
    v_mul_f32 v178, v82, v178
    v_mul_f32 v179, v83, v179
    v_mul_f32 v180, v84, v180
    v_mul_f32 v181, v85, v181
    v_mul_f32 v182, v86, v182
    v_mul_f32 v183, v87, v183
    s_setprio 2
    s_waitcnt lgkmcnt(0)
    v_mfma_f32_32x32x16_bf16 v[16:31], v[144:147], v[172:175], v[16:31]
    v_cvt_pk_bf16_f32 v168, v64, v65
    v_cvt_pk_bf16_f32 v169, v66, v67
    v_rcp_f32 v184, v184
    v_rcp_f32 v185, v185
    v_mfma_f32_32x32x16_bf16 v[32:47], v[148:151], v[172:175], v[32:47]
    v_cvt_pk_bf16_f32 v170, v68, v69
    v_cvt_pk_bf16_f32 v171, v70, v71
    v_rcp_f32 v186, v186
    v_rcp_f32 v187, v187
    v_mfma_f32_32x32x16_bf16 v[48:63], v[152:155], v[172:175], v[48:63]
    v_rcp_f32 v188, v188
    v_rcp_f32 v189, v189
    v_rcp_f32 v190, v190
    v_mfma_f32_32x32x16_bf16 v[16:31], v[156:159], v[168:171], v[16:31]
    v_rcp_f32 v191, v191
    v_exp_f32 v176, v176
    v_exp_f32 v177, v177
    v_mfma_f32_32x32x16_bf16 v[32:47], v[160:163], v[168:171], v[32:47]
    v_exp_f32 v178, v178
    v_exp_f32 v179, v179
    v_exp_f32 v180, v180
    v_mfma_f32_32x32x16_bf16 v[48:63], v[164:167], v[168:171], v[48:63]
    v_exp_f32 v181, v181
    v_exp_f32 v182, v182
    v_exp_f32 v183, v183
    s_setprio 0
    ds_read_b128 v[192:195], v6 offset:0
    ds_read_b128 v[196:199], v6 offset:32
    ds_read_b128 v[200:203], v6 offset:64
    ds_read_b128 v[204:207], v6 offset:96
    ds_read_b64_tr_b16 v[120:121], v4 offset:0
    ds_read_b64_tr_b16 v[122:123], v4 offset:1024
    ds_read_b64_tr_b16 v[124:125], v4 offset:2048
    ds_read_b64_tr_b16 v[126:127], v4 offset:3072
    ds_read_b64_tr_b16 v[128:129], v4 offset:4096
    ds_read_b64_tr_b16 v[130:131], v4 offset:5120
    ds_read_b64_tr_b16 v[132:133], v4 offset:6144
    ds_read_b64_tr_b16 v[134:135], v4 offset:7168
    ds_read_b64_tr_b16 v[136:137], v4 offset:8192
    ds_read_b64_tr_b16 v[138:139], v4 offset:9216
    ds_read_b64_tr_b16 v[140:141], v4 offset:10240
    ds_read_b64_tr_b16 v[142:143], v4 offset:11264
    v_add_f32 v176, 1.0, v176
    v_add_f32 v177, 1.0, v177
    v_add_f32 v178, 1.0, v178
    v_add_f32 v179, 1.0, v179
    v_add_f32 v180, 1.0, v180
    v_add_f32 v181, 1.0, v181
    v_add_f32 v182, 1.0, v182
    v_add_f32 v183, 1.0, v183
    v_mul_f32 v1, v72, v184
    v_mul_f32 v2, v73, v185
    v_mul_f32 v3, v74, v186
    v_mul_f32 v10, v75, v187
    v_mul_f32 v11, v76, v188
    v_mul_f32 v12, v77, v189
    v_mul_f32 v13, v78, v190
    v_mul_f32 v14, v79, v191
    v_fmaak_f32 v184, v88, v88, 0x409d30fc
    v_fmaak_f32 v185, v89, v89, 0x409d30fc
    v_fmaak_f32 v186, v90, v90, 0x409d30fc
    v_fmaak_f32 v187, v91, v91, 0x409d30fc
    v_fmaak_f32 v188, v92, v92, 0x409d30fc
    v_fmaak_f32 v189, v93, v93, 0x409d30fc
    v_fmaak_f32 v190, v94, v94, 0x409d30fc
    v_fmaak_f32 v191, v95, v95, 0x409d30fc
    v_mul_f32 v184, v88, v184
    v_mul_f32 v185, v89, v185
    v_mul_f32 v186, v90, v186
    v_mul_f32 v187, v91, v187
    v_mul_f32 v188, v92, v188
    v_mul_f32 v189, v93, v189
    v_mul_f32 v190, v94, v190
    v_mul_f32 v191, v95, v191
    s_setprio 2
    s_waitcnt lgkmcnt(0)
    v_mfma_f32_32x32x16_bf16 v[64:79], v[120:123], v[96:99], v[192:207]
    v_cvt_pk_bf16_f32 v172, v1, v2
    v_cvt_pk_bf16_f32 v173, v3, v10
    v_rcp_f32 v176, v176
    v_rcp_f32 v177, v177
    v_mfma_f32_32x32x16_bf16 v[64:79], v[124:127], v[100:103], v[64:79]
    v_cvt_pk_bf16_f32 v174, v11, v12
    v_cvt_pk_bf16_f32 v175, v13, v14
    v_rcp_f32 v178, v178
    v_rcp_f32 v179, v179
    v_mfma_f32_32x32x16_bf16 v[64:79], v[128:131], v[104:107], v[64:79]
    v_rcp_f32 v180, v180
    v_rcp_f32 v181, v181
    v_rcp_f32 v182, v182
    v_mfma_f32_32x32x16_bf16 v[64:79], v[132:135], v[108:111], v[64:79]
    v_rcp_f32 v183, v183
    v_exp_f32 v184, v184
    v_exp_f32 v185, v185
    v_mfma_f32_32x32x16_bf16 v[64:79], v[136:139], v[112:115], v[64:79]
    v_exp_f32 v186, v186
    v_exp_f32 v187, v187
    v_exp_f32 v188, v188
    v_mfma_f32_32x32x16_bf16 v[64:79], v[140:143], v[116:119], v[64:79]
    v_exp_f32 v189, v189
    v_exp_f32 v190, v190
    v_exp_f32 v191, v191
    s_setprio 0
    ds_read_b64_tr_b16 v[144:145], v5 offset:21504
    ds_read_b64_tr_b16 v[146:147], v5 offset:23040
    ds_read_b64_tr_b16 v[148:149], v5 offset:21568
    ds_read_b64_tr_b16 v[150:151], v5 offset:23104
    ds_read_b64_tr_b16 v[152:153], v5 offset:21632
    ds_read_b64_tr_b16 v[154:155], v5 offset:23168
    ds_read_b64_tr_b16 v[156:157], v5 offset:36864
    ds_read_b64_tr_b16 v[158:159], v5 offset:38400
    ds_read_b64_tr_b16 v[160:161], v5 offset:36928
    ds_read_b64_tr_b16 v[162:163], v5 offset:38464
    ds_read_b64_tr_b16 v[164:165], v5 offset:36992
    ds_read_b64_tr_b16 v[166:167], v5 offset:38528
    v_add_f32 v184, 1.0, v184
    v_add_f32 v185, 1.0, v185
    v_add_f32 v186, 1.0, v186
    v_add_f32 v187, 1.0, v187
    v_add_f32 v188, 1.0, v188
    v_add_f32 v189, 1.0, v189
    v_add_f32 v190, 1.0, v190
    v_add_f32 v191, 1.0, v191
    v_mul_f32 v80, v80, v176
    v_mul_f32 v81, v81, v177
    v_mul_f32 v82, v82, v178
    v_mul_f32 v83, v83, v179
    v_mul_f32 v84, v84, v180
    v_mul_f32 v85, v85, v181
    v_mul_f32 v86, v86, v182
    v_mul_f32 v87, v87, v183
    v_fmaak_f32 v176, v64, v64, 0x409d30fc
    v_fmaak_f32 v177, v65, v65, 0x409d30fc
    v_fmaak_f32 v178, v66, v66, 0x409d30fc
    v_fmaak_f32 v179, v67, v67, 0x409d30fc
    v_fmaak_f32 v180, v68, v68, 0x409d30fc
    v_fmaak_f32 v181, v69, v69, 0x409d30fc
    v_fmaak_f32 v182, v70, v70, 0x409d30fc
    v_fmaak_f32 v183, v71, v71, 0x409d30fc
    v_mul_f32 v176, v64, v176
    v_mul_f32 v177, v65, v177
    v_mul_f32 v178, v66, v178
    v_mul_f32 v179, v67, v179
    v_mul_f32 v180, v68, v180
    v_mul_f32 v181, v69, v181
    v_mul_f32 v182, v70, v182
    v_mul_f32 v183, v71, v183
    s_setprio 2
    s_waitcnt lgkmcnt(0)
    v_mfma_f32_32x32x16_bf16 v[16:31], v[144:147], v[172:175], v[16:31]
    v_cvt_pk_bf16_f32 v168, v80, v81
    v_cvt_pk_bf16_f32 v169, v82, v83
    v_rcp_f32 v184, v184
    v_rcp_f32 v185, v185
    v_mfma_f32_32x32x16_bf16 v[32:47], v[148:151], v[172:175], v[32:47]
    v_cvt_pk_bf16_f32 v170, v84, v85
    v_cvt_pk_bf16_f32 v171, v86, v87
    v_rcp_f32 v186, v186
    v_rcp_f32 v187, v187
    v_mfma_f32_32x32x16_bf16 v[48:63], v[152:155], v[172:175], v[48:63]
    v_rcp_f32 v188, v188
    v_rcp_f32 v189, v189
    v_rcp_f32 v190, v190
    v_mfma_f32_32x32x16_bf16 v[16:31], v[156:159], v[168:171], v[16:31]
    v_rcp_f32 v191, v191
    v_exp_f32 v176, v176
    v_exp_f32 v177, v177
    v_mfma_f32_32x32x16_bf16 v[32:47], v[160:163], v[168:171], v[32:47]
    v_exp_f32 v178, v178
    v_exp_f32 v179, v179
    v_exp_f32 v180, v180
    v_mfma_f32_32x32x16_bf16 v[48:63], v[164:167], v[168:171], v[48:63]
    v_exp_f32 v181, v181
    v_exp_f32 v182, v182
    v_exp_f32 v183, v183
    s_setprio 0
    ds_read_b128 v[192:195], v6 offset:128
    ds_read_b128 v[196:199], v6 offset:160
    ds_read_b128 v[200:203], v6 offset:192
    ds_read_b128 v[204:207], v6 offset:224
    ds_read_b64_tr_b16 v[120:121], v4 offset:512
    ds_read_b64_tr_b16 v[122:123], v4 offset:1536
    ds_read_b64_tr_b16 v[124:125], v4 offset:2560
    ds_read_b64_tr_b16 v[126:127], v4 offset:3584
    ds_read_b64_tr_b16 v[128:129], v4 offset:4608
    ds_read_b64_tr_b16 v[130:131], v4 offset:5632
    ds_read_b64_tr_b16 v[132:133], v4 offset:6656
    ds_read_b64_tr_b16 v[134:135], v4 offset:7680
    ds_read_b64_tr_b16 v[136:137], v4 offset:8704
    ds_read_b64_tr_b16 v[138:139], v4 offset:9728
    ds_read_b64_tr_b16 v[140:141], v4 offset:10752
    ds_read_b64_tr_b16 v[142:143], v4 offset:11776
    ds_read_b32 v0, v15 offset:4
    v_add_f32 v176, 1.0, v176
    v_add_f32 v177, 1.0, v177
    v_add_f32 v178, 1.0, v178
    v_add_f32 v179, 1.0, v179
    v_add_f32 v180, 1.0, v180
    v_add_f32 v181, 1.0, v181
    v_add_f32 v182, 1.0, v182
    v_add_f32 v183, 1.0, v183
    v_mul_f32 v1, v88, v184
    v_mul_f32 v2, v89, v185
    v_mul_f32 v3, v90, v186
    v_mul_f32 v10, v91, v187
    v_mul_f32 v11, v92, v188
    v_mul_f32 v12, v93, v189
    v_mul_f32 v13, v94, v190
    v_mul_f32 v14, v95, v191
    v_fmaak_f32 v184, v72, v72, 0x409d30fc
    v_fmaak_f32 v185, v73, v73, 0x409d30fc
    v_fmaak_f32 v186, v74, v74, 0x409d30fc
    v_fmaak_f32 v187, v75, v75, 0x409d30fc
    v_fmaak_f32 v188, v76, v76, 0x409d30fc
    v_fmaak_f32 v189, v77, v77, 0x409d30fc
    v_fmaak_f32 v190, v78, v78, 0x409d30fc
    v_fmaak_f32 v191, v79, v79, 0x409d30fc
    v_mul_f32 v184, v72, v184
    v_mul_f32 v185, v73, v185
    v_mul_f32 v186, v74, v186
    v_mul_f32 v187, v75, v187
    v_mul_f32 v188, v76, v188
    v_mul_f32 v189, v77, v189
    v_mul_f32 v190, v78, v190
    v_mul_f32 v191, v79, v191
    s_setprio 2
    s_waitcnt lgkmcnt(0)
    v_mfma_f32_32x32x16_bf16 v[80:95], v[120:123], v[96:99], v[192:207]
    v_cvt_pk_bf16_f32 v172, v1, v2
    v_cvt_pk_bf16_f32 v173, v3, v10
    v_rcp_f32 v176, v176
    v_rcp_f32 v177, v177
    v_mfma_f32_32x32x16_bf16 v[80:95], v[124:127], v[100:103], v[80:95]
    v_cvt_pk_bf16_f32 v174, v11, v12
    v_cvt_pk_bf16_f32 v175, v13, v14
    v_rcp_f32 v178, v178
    v_rcp_f32 v179, v179
    v_mfma_f32_32x32x16_bf16 v[80:95], v[128:131], v[104:107], v[80:95]
    v_rcp_f32 v180, v180
    v_rcp_f32 v181, v181
    v_rcp_f32 v182, v182
    v_mfma_f32_32x32x16_bf16 v[80:95], v[132:135], v[108:111], v[80:95]
    v_rcp_f32 v183, v183
    v_exp_f32 v184, v184
    v_exp_f32 v185, v185
    v_mfma_f32_32x32x16_bf16 v[80:95], v[136:139], v[112:115], v[80:95]
    v_exp_f32 v186, v186
    v_exp_f32 v187, v187
    v_exp_f32 v188, v188
    v_mfma_f32_32x32x16_bf16 v[80:95], v[140:143], v[116:119], v[80:95]
    v_exp_f32 v189, v189
    v_exp_f32 v190, v190
    v_exp_f32 v191, v191
    v_readfirstlane_b32 s54, v0
    s_setprio 0
    s_add_u32 s54, s54, 0x79797979
    s_andn2_b32 s54, 0x80808080, s54
    s_cbranch_scc0 L_needH13_ok
L_needH13:
    ds_read_b32 v0, v15 offset:4
    s_waitcnt lgkmcnt(0)
    v_readfirstlane_b32 s54, v0
    s_nop 0
    s_add_u32 s54, s54, 0x79797979
    s_andn2_b32 s54, 0x80808080, s54
    s_cbranch_scc1 L_needH13
L_needH13_ok:
    ds_read_b64_tr_b16 v[144:145], v5 offset:39936
    ds_read_b64_tr_b16 v[146:147], v5 offset:41472
    ds_read_b64_tr_b16 v[148:149], v5 offset:40000
    ds_read_b64_tr_b16 v[150:151], v5 offset:41536
    ds_read_b64_tr_b16 v[152:153], v5 offset:40064
    ds_read_b64_tr_b16 v[154:155], v5 offset:41600
    ds_read_b64_tr_b16 v[156:157], v5 offset:12288
    ds_read_b64_tr_b16 v[158:159], v5 offset:13824
    ds_read_b64_tr_b16 v[160:161], v5 offset:12352
    ds_read_b64_tr_b16 v[162:163], v5 offset:13888
    ds_read_b64_tr_b16 v[164:165], v5 offset:12416
    ds_read_b64_tr_b16 v[166:167], v5 offset:13952
    ds_read_b32 v0, v15 offset:0
    v_add_f32 v184, 1.0, v184
    v_add_f32 v185, 1.0, v185
    v_add_f32 v186, 1.0, v186
    v_add_f32 v187, 1.0, v187
    v_add_f32 v188, 1.0, v188
    v_add_f32 v189, 1.0, v189
    v_add_f32 v190, 1.0, v190
    v_add_f32 v191, 1.0, v191
    v_mul_f32 v64, v64, v176
    v_mul_f32 v65, v65, v177
    v_mul_f32 v66, v66, v178
    v_mul_f32 v67, v67, v179
    v_mul_f32 v68, v68, v180
    v_mul_f32 v69, v69, v181
    v_mul_f32 v70, v70, v182
    v_mul_f32 v71, v71, v183
    v_fmaak_f32 v176, v80, v80, 0x409d30fc
    v_fmaak_f32 v177, v81, v81, 0x409d30fc
    v_fmaak_f32 v178, v82, v82, 0x409d30fc
    v_fmaak_f32 v179, v83, v83, 0x409d30fc
    v_fmaak_f32 v180, v84, v84, 0x409d30fc
    v_fmaak_f32 v181, v85, v85, 0x409d30fc
    v_fmaak_f32 v182, v86, v86, 0x409d30fc
    v_fmaak_f32 v183, v87, v87, 0x409d30fc
    v_mul_f32 v176, v80, v176
    v_mul_f32 v177, v81, v177
    v_mul_f32 v178, v82, v178
    v_mul_f32 v179, v83, v179
    v_mul_f32 v180, v84, v180
    v_mul_f32 v181, v85, v181
    v_mul_f32 v182, v86, v182
    v_mul_f32 v183, v87, v183
    v_add_u32 v8, 49152, v9
    s_setprio 2
    s_waitcnt lgkmcnt(0)
    v_mfma_f32_32x32x16_bf16 v[16:31], v[144:147], v[172:175], v[16:31]
    v_cvt_pk_bf16_f32 v168, v64, v65
    v_cvt_pk_bf16_f32 v169, v66, v67
    v_rcp_f32 v184, v184
    v_rcp_f32 v185, v185
    v_mfma_f32_32x32x16_bf16 v[32:47], v[148:151], v[172:175], v[32:47]
    v_cvt_pk_bf16_f32 v170, v68, v69
    v_cvt_pk_bf16_f32 v171, v70, v71
    v_rcp_f32 v186, v186
    v_rcp_f32 v187, v187
    v_mfma_f32_32x32x16_bf16 v[48:63], v[152:155], v[172:175], v[48:63]
    v_rcp_f32 v188, v188
    v_rcp_f32 v189, v189
    v_rcp_f32 v190, v190
    v_mfma_f32_32x32x16_bf16 v[208:223], v[156:159], v[168:171], 0
    v_rcp_f32 v191, v191
    v_exp_f32 v176, v176
    v_exp_f32 v177, v177
    v_mfma_f32_32x32x16_bf16 v[224:239], v[160:163], v[168:171], 0
    v_exp_f32 v178, v178
    v_exp_f32 v179, v179
    v_exp_f32 v180, v180
    v_mfma_f32_32x32x16_bf16 v[240:255], v[164:167], v[168:171], 0
    v_exp_f32 v181, v181
    v_exp_f32 v182, v182
    v_exp_f32 v183, v183
    v_readfirstlane_b32 s54, v0
    s_setprio 0
    s_add_u32 s54, s54, 0x78787878
    s_andn2_b32 s54, 0x80808080, s54
    s_cbranch_scc0 L_needH14_ok
L_needH14:
    ds_read_b32 v0, v15 offset:0
    s_waitcnt lgkmcnt(0)
    v_readfirstlane_b32 s54, v0
    s_nop 0
    s_add_u32 s54, s54, 0x78787878
    s_andn2_b32 s54, 0x80808080, s54
    s_cbranch_scc1 L_needH14
L_needH14_ok:
    ds_read_b128 v[192:195], v6 offset:256
    ds_read_b128 v[196:199], v6 offset:288
    ds_read_b128 v[200:203], v6 offset:320
    ds_read_b128 v[204:207], v6 offset:352
    ds_read_b64_tr_b16 v[120:121], v4 offset:24576
    ds_read_b64_tr_b16 v[122:123], v4 offset:25600
    ds_read_b64_tr_b16 v[124:125], v4 offset:26624
    ds_read_b64_tr_b16 v[126:127], v4 offset:27648
    ds_read_b64_tr_b16 v[128:129], v4 offset:28672
    ds_read_b64_tr_b16 v[130:131], v4 offset:29696
    ds_read_b64_tr_b16 v[132:133], v4 offset:30720
    ds_read_b64_tr_b16 v[134:135], v4 offset:31744
    ds_read_b64_tr_b16 v[136:137], v4 offset:32768
    ds_read_b64_tr_b16 v[138:139], v4 offset:33792
    ds_read_b64_tr_b16 v[140:141], v4 offset:34816
    ds_read_b64_tr_b16 v[142:143], v4 offset:35840
    ds_write_b128 v8, v[16:19] offset:0
    ds_write_b128 v8, v[20:23] offset:1024
    ds_write_b128 v8, v[24:27] offset:2048
    ds_write_b128 v8, v[28:31] offset:3072
    v_add_f32 v176, 1.0, v176
    v_add_f32 v177, 1.0, v177
    v_add_f32 v178, 1.0, v178
    v_add_f32 v179, 1.0, v179
    v_add_f32 v180, 1.0, v180
    v_add_f32 v181, 1.0, v181
    v_add_f32 v182, 1.0, v182
    v_add_f32 v183, 1.0, v183
    v_mul_f32 v1, v72, v184
    v_mul_f32 v2, v73, v185
    v_mul_f32 v3, v74, v186
    v_mul_f32 v10, v75, v187
    v_mul_f32 v11, v76, v188
    v_mul_f32 v12, v77, v189
    v_mul_f32 v13, v78, v190
    v_mul_f32 v14, v79, v191
    v_fmaak_f32 v184, v88, v88, 0x409d30fc
    v_fmaak_f32 v185, v89, v89, 0x409d30fc
    v_fmaak_f32 v186, v90, v90, 0x409d30fc
    v_fmaak_f32 v187, v91, v91, 0x409d30fc
    v_fmaak_f32 v188, v92, v92, 0x409d30fc
    v_fmaak_f32 v189, v93, v93, 0x409d30fc
    v_fmaak_f32 v190, v94, v94, 0x409d30fc
    v_fmaak_f32 v191, v95, v95, 0x409d30fc
    v_mul_f32 v184, v88, v184
    v_mul_f32 v185, v89, v185
    v_mul_f32 v186, v90, v186
    v_mul_f32 v187, v91, v187
    v_mul_f32 v188, v92, v188
    v_mul_f32 v189, v93, v189
    v_mul_f32 v190, v94, v190
    v_mul_f32 v191, v95, v191
    s_setprio 2
    s_waitcnt lgkmcnt(0)
    v_mfma_f32_32x32x16_bf16 v[64:79], v[120:123], v[96:99], v[192:207]
    v_cvt_pk_bf16_f32 v172, v1, v2
    v_cvt_pk_bf16_f32 v173, v3, v10
    v_rcp_f32 v176, v176
    v_rcp_f32 v177, v177
    v_mfma_f32_32x32x16_bf16 v[64:79], v[124:127], v[100:103], v[64:79]
    v_cvt_pk_bf16_f32 v174, v11, v12
    v_cvt_pk_bf16_f32 v175, v13, v14
    v_rcp_f32 v178, v178
    v_rcp_f32 v179, v179
    v_mfma_f32_32x32x16_bf16 v[64:79], v[128:131], v[104:107], v[64:79]
    v_rcp_f32 v180, v180
    v_rcp_f32 v181, v181
    v_rcp_f32 v182, v182
    v_mfma_f32_32x32x16_bf16 v[64:79], v[132:135], v[108:111], v[64:79]
    v_rcp_f32 v183, v183
    v_exp_f32 v184, v184
    v_exp_f32 v185, v185
    v_mfma_f32_32x32x16_bf16 v[64:79], v[136:139], v[112:115], v[64:79]
    v_exp_f32 v186, v186
    v_exp_f32 v187, v187
    v_exp_f32 v188, v188
    v_mfma_f32_32x32x16_bf16 v[64:79], v[140:143], v[116:119], v[64:79]
    v_exp_f32 v189, v189
    v_exp_f32 v190, v190
    v_exp_f32 v191, v191
    s_setprio 0
    ds_read_b64_tr_b16 v[144:145], v5 offset:15360
    ds_read_b64_tr_b16 v[146:147], v5 offset:16896
    ds_read_b64_tr_b16 v[148:149], v5 offset:15424
    ds_read_b64_tr_b16 v[150:151], v5 offset:16960
    ds_read_b64_tr_b16 v[152:153], v5 offset:15488
    ds_read_b64_tr_b16 v[154:155], v5 offset:17024
    ds_read_b64_tr_b16 v[156:157], v5 offset:18432
    ds_read_b64_tr_b16 v[158:159], v5 offset:19968
    ds_read_b64_tr_b16 v[160:161], v5 offset:18496
    ds_read_b64_tr_b16 v[162:163], v5 offset:20032
    ds_read_b64_tr_b16 v[164:165], v5 offset:18560
    ds_read_b64_tr_b16 v[166:167], v5 offset:20096
    ds_read_b128 v[96:99], v7 offset:6144
    ds_read_b128 v[100:103], v7 offset:7168
    ds_read_b128 v[104:107], v7 offset:8192
    ds_read_b128 v[108:111], v7 offset:9216
    ds_read_b128 v[112:115], v7 offset:10240
    ds_read_b128 v[116:119], v7 offset:11264
    ds_write_b128 v8, v[32:35] offset:4096
    ds_write_b128 v8, v[36:39] offset:5120
    ds_write_b128 v8, v[40:43] offset:6144
    ds_write_b128 v8, v[44:47] offset:7168
    v_add_f32 v184, 1.0, v184
    v_add_f32 v185, 1.0, v185
    v_add_f32 v186, 1.0, v186
    v_add_f32 v187, 1.0, v187
    v_add_f32 v188, 1.0, v188
    v_add_f32 v189, 1.0, v189
    v_add_f32 v190, 1.0, v190
    v_add_f32 v191, 1.0, v191
    v_mul_f32 v80, v80, v176
    v_mul_f32 v81, v81, v177
    v_mul_f32 v82, v82, v178
    v_mul_f32 v83, v83, v179
    v_mul_f32 v84, v84, v180
    v_mul_f32 v85, v85, v181
    v_mul_f32 v86, v86, v182
    v_mul_f32 v87, v87, v183
    v_fmaak_f32 v176, v64, v64, 0x409d30fc
    v_fmaak_f32 v177, v65, v65, 0x409d30fc
    v_fmaak_f32 v178, v66, v66, 0x409d30fc
    v_fmaak_f32 v179, v67, v67, 0x409d30fc
    v_fmaak_f32 v180, v68, v68, 0x409d30fc
    v_fmaak_f32 v181, v69, v69, 0x409d30fc
    v_fmaak_f32 v182, v70, v70, 0x409d30fc
    v_fmaak_f32 v183, v71, v71, 0x409d30fc
    v_mul_f32 v176, v64, v176
    v_mul_f32 v177, v65, v177
    v_mul_f32 v178, v66, v178
    v_mul_f32 v179, v67, v179
    v_mul_f32 v180, v68, v180
    v_mul_f32 v181, v69, v181
    v_mul_f32 v182, v70, v182
    v_mul_f32 v183, v71, v183
    v_mov_b32 v0, 1
    s_setprio 2
    s_waitcnt lgkmcnt(0)
    v_mfma_f32_32x32x16_bf16 v[208:223], v[144:147], v[172:175], v[208:223]
    v_cvt_pk_bf16_f32 v168, v80, v81
    v_cvt_pk_bf16_f32 v169, v82, v83
    v_rcp_f32 v184, v184
    v_rcp_f32 v185, v185
    v_mfma_f32_32x32x16_bf16 v[224:239], v[148:151], v[172:175], v[224:239]
    v_cvt_pk_bf16_f32 v170, v84, v85
    v_cvt_pk_bf16_f32 v171, v86, v87
    v_rcp_f32 v186, v186
    v_rcp_f32 v187, v187
    v_mfma_f32_32x32x16_bf16 v[240:255], v[152:155], v[172:175], v[240:255]
    v_rcp_f32 v188, v188
    v_rcp_f32 v189, v189
    v_rcp_f32 v190, v190
    v_mfma_f32_32x32x16_bf16 v[208:223], v[156:159], v[168:171], v[208:223]
    v_rcp_f32 v191, v191
    v_exp_f32 v176, v176
    v_exp_f32 v177, v177
    v_mfma_f32_32x32x16_bf16 v[224:239], v[160:163], v[168:171], v[224:239]
    v_exp_f32 v178, v178
    v_exp_f32 v179, v179
    v_exp_f32 v180, v180
    v_mfma_f32_32x32x16_bf16 v[240:255], v[164:167], v[168:171], v[240:255]
    v_exp_f32 v181, v181
    v_exp_f32 v182, v182
    v_exp_f32 v183, v183
    s_setprio 0
    ds_read_b128 v[192:195], v6 offset:0
    ds_read_b128 v[196:199], v6 offset:32
    ds_read_b128 v[200:203], v6 offset:64
    ds_read_b128 v[204:207], v6 offset:96
    ds_read_b64_tr_b16 v[120:121], v4 offset:0
    ds_read_b64_tr_b16 v[122:123], v4 offset:1024
    ds_read_b64_tr_b16 v[124:125], v4 offset:2048
    ds_read_b64_tr_b16 v[126:127], v4 offset:3072
    ds_read_b64_tr_b16 v[128:129], v4 offset:4096
    ds_read_b64_tr_b16 v[130:131], v4 offset:5120
    ds_read_b64_tr_b16 v[132:133], v4 offset:6144
    ds_read_b64_tr_b16 v[134:135], v4 offset:7168
    ds_read_b64_tr_b16 v[136:137], v4 offset:8192
    ds_read_b64_tr_b16 v[138:139], v4 offset:9216
    ds_read_b64_tr_b16 v[140:141], v4 offset:10240
    ds_read_b64_tr_b16 v[142:143], v4 offset:11264
    ds_write_b128 v8, v[48:51] offset:8192
    ds_write_b128 v8, v[52:55] offset:9216
    ds_write_b128 v8, v[56:59] offset:10240
    ds_write_b128 v8, v[60:63] offset:11264
    ds_write_b8 v15, v0 offset:11
    v_add_f32 v176, 1.0, v176
    v_add_f32 v177, 1.0, v177
    v_add_f32 v178, 1.0, v178
    v_add_f32 v179, 1.0, v179
    v_add_f32 v180, 1.0, v180
    v_add_f32 v181, 1.0, v181
    v_add_f32 v182, 1.0, v182
    v_add_f32 v183, 1.0, v183
    v_mul_f32 v1, v88, v184
    v_mul_f32 v2, v89, v185
    v_mul_f32 v3, v90, v186
    v_mul_f32 v10, v91, v187
    v_mul_f32 v11, v92, v188
    v_mul_f32 v12, v93, v189
    v_mul_f32 v13, v94, v190
    v_mul_f32 v14, v95, v191
    v_fmaak_f32 v184, v72, v72, 0x409d30fc
    v_fmaak_f32 v185, v73, v73, 0x409d30fc
    v_fmaak_f32 v186, v74, v74, 0x409d30fc
    v_fmaak_f32 v187, v75, v75, 0x409d30fc
    v_fmaak_f32 v188, v76, v76, 0x409d30fc
    v_fmaak_f32 v189, v77, v77, 0x409d30fc
    v_fmaak_f32 v190, v78, v78, 0x409d30fc
    v_fmaak_f32 v191, v79, v79, 0x409d30fc
    v_mul_f32 v184, v72, v184
    v_mul_f32 v185, v73, v185
    v_mul_f32 v186, v74, v186
    v_mul_f32 v187, v75, v187
    v_mul_f32 v188, v76, v188
    v_mul_f32 v189, v77, v189
    v_mul_f32 v190, v78, v190
    v_mul_f32 v191, v79, v191
    s_setprio 2
    s_waitcnt lgkmcnt(0)
    v_mfma_f32_32x32x16_bf16 v[80:95], v[120:123], v[96:99], v[192:207]
    v_cvt_pk_bf16_f32 v172, v1, v2
    v_cvt_pk_bf16_f32 v173, v3, v10
    v_rcp_f32 v176, v176
    v_rcp_f32 v177, v177
    v_mfma_f32_32x32x16_bf16 v[80:95], v[124:127], v[100:103], v[80:95]
    v_cvt_pk_bf16_f32 v174, v11, v12
    v_cvt_pk_bf16_f32 v175, v13, v14
    v_rcp_f32 v178, v178
    v_rcp_f32 v179, v179
    v_mfma_f32_32x32x16_bf16 v[80:95], v[128:131], v[104:107], v[80:95]
    v_rcp_f32 v180, v180
    v_rcp_f32 v181, v181
    v_rcp_f32 v182, v182
    v_mfma_f32_32x32x16_bf16 v[80:95], v[132:135], v[108:111], v[80:95]
    v_rcp_f32 v183, v183
    v_exp_f32 v184, v184
    v_exp_f32 v185, v185
    v_mfma_f32_32x32x16_bf16 v[80:95], v[136:139], v[112:115], v[80:95]
    v_exp_f32 v186, v186
    v_exp_f32 v187, v187
    v_exp_f32 v188, v188
    v_mfma_f32_32x32x16_bf16 v[80:95], v[140:143], v[116:119], v[80:95]
    v_exp_f32 v189, v189
    v_exp_f32 v190, v190
    v_exp_f32 v191, v191
    s_setprio 0
    ds_read_b64_tr_b16 v[144:145], v5 offset:21504
    ds_read_b64_tr_b16 v[146:147], v5 offset:23040
    ds_read_b64_tr_b16 v[148:149], v5 offset:21568
    ds_read_b64_tr_b16 v[150:151], v5 offset:23104
    ds_read_b64_tr_b16 v[152:153], v5 offset:21632
    ds_read_b64_tr_b16 v[154:155], v5 offset:23168
    ds_read_b64_tr_b16 v[156:157], v5 offset:36864
    ds_read_b64_tr_b16 v[158:159], v5 offset:38400
    ds_read_b64_tr_b16 v[160:161], v5 offset:36928
    ds_read_b64_tr_b16 v[162:163], v5 offset:38464
    ds_read_b64_tr_b16 v[164:165], v5 offset:36992
    ds_read_b64_tr_b16 v[166:167], v5 offset:38528
    ds_read_b32 v0, v15 offset:4
    v_add_f32 v184, 1.0, v184
    v_add_f32 v185, 1.0, v185
    v_add_f32 v186, 1.0, v186
    v_add_f32 v187, 1.0, v187
    v_add_f32 v188, 1.0, v188
    v_add_f32 v189, 1.0, v189
    v_add_f32 v190, 1.0, v190
    v_add_f32 v191, 1.0, v191
    v_mul_f32 v64, v64, v176
    v_mul_f32 v65, v65, v177
    v_mul_f32 v66, v66, v178
    v_mul_f32 v67, v67, v179
    v_mul_f32 v68, v68, v180
    v_mul_f32 v69, v69, v181
    v_mul_f32 v70, v70, v182
    v_mul_f32 v71, v71, v183
    v_fmaak_f32 v176, v80, v80, 0x409d30fc
    v_fmaak_f32 v177, v81, v81, 0x409d30fc
    v_fmaak_f32 v178, v82, v82, 0x409d30fc
    v_fmaak_f32 v179, v83, v83, 0x409d30fc
    v_fmaak_f32 v180, v84, v84, 0x409d30fc
    v_fmaak_f32 v181, v85, v85, 0x409d30fc
    v_fmaak_f32 v182, v86, v86, 0x409d30fc
    v_fmaak_f32 v183, v87, v87, 0x409d30fc
    v_mul_f32 v176, v80, v176
    v_mul_f32 v177, v81, v177
    v_mul_f32 v178, v82, v178
    v_mul_f32 v179, v83, v179
    v_mul_f32 v180, v84, v180
    v_mul_f32 v181, v85, v181
    v_mul_f32 v182, v86, v182
    v_mul_f32 v183, v87, v183
    s_setprio 2
    s_waitcnt lgkmcnt(0)
    v_mfma_f32_32x32x16_bf16 v[208:223], v[144:147], v[172:175], v[208:223]
    v_cvt_pk_bf16_f32 v168, v64, v65
    v_cvt_pk_bf16_f32 v169, v66, v67
    v_rcp_f32 v184, v184
    v_rcp_f32 v185, v185
    v_mfma_f32_32x32x16_bf16 v[224:239], v[148:151], v[172:175], v[224:239]
    v_cvt_pk_bf16_f32 v170, v68, v69
    v_cvt_pk_bf16_f32 v171, v70, v71
    v_rcp_f32 v186, v186
    v_rcp_f32 v187, v187
    v_mfma_f32_32x32x16_bf16 v[240:255], v[152:155], v[172:175], v[240:255]
    v_rcp_f32 v188, v188
    v_rcp_f32 v189, v189
    v_rcp_f32 v190, v190
    v_mfma_f32_32x32x16_bf16 v[208:223], v[156:159], v[168:171], v[208:223]
    v_rcp_f32 v191, v191
    v_exp_f32 v176, v176
    v_exp_f32 v177, v177
    v_mfma_f32_32x32x16_bf16 v[224:239], v[160:163], v[168:171], v[224:239]
    v_exp_f32 v178, v178
    v_exp_f32 v179, v179
    v_exp_f32 v180, v180
    v_mfma_f32_32x32x16_bf16 v[240:255], v[164:167], v[168:171], v[240:255]
    v_exp_f32 v181, v181
    v_exp_f32 v182, v182
    v_exp_f32 v183, v183
    v_readfirstlane_b32 s54, v0
    s_setprio 0
    s_add_u32 s54, s54, 0x78787878
    s_andn2_b32 s54, 0x80808080, s54
    s_cbranch_scc0 L_needH18_ok
L_needH18:
    ds_read_b32 v0, v15 offset:4
    s_waitcnt lgkmcnt(0)
    v_readfirstlane_b32 s54, v0
    s_nop 0
    s_add_u32 s54, s54, 0x78787878
    s_andn2_b32 s54, 0x80808080, s54
    s_cbranch_scc1 L_needH18
L_needH18_ok:
    ds_read_b128 v[192:195], v6 offset:128
    ds_read_b128 v[196:199], v6 offset:160
    ds_read_b128 v[200:203], v6 offset:192
    ds_read_b128 v[204:207], v6 offset:224
    ds_read_b64_tr_b16 v[120:121], v4 offset:512
    ds_read_b64_tr_b16 v[122:123], v4 offset:1536
    ds_read_b64_tr_b16 v[124:125], v4 offset:2560
    ds_read_b64_tr_b16 v[126:127], v4 offset:3584
    ds_read_b64_tr_b16 v[128:129], v4 offset:4608
    ds_read_b64_tr_b16 v[130:131], v4 offset:5632
    ds_read_b64_tr_b16 v[132:133], v4 offset:6656
    ds_read_b64_tr_b16 v[134:135], v4 offset:7680
    ds_read_b64_tr_b16 v[136:137], v4 offset:8704
    ds_read_b64_tr_b16 v[138:139], v4 offset:9728
    ds_read_b64_tr_b16 v[140:141], v4 offset:10752
    ds_read_b64_tr_b16 v[142:143], v4 offset:11776
    ds_read_b32 v0, v15 offset:0
    v_add_f32 v176, 1.0, v176
    v_add_f32 v177, 1.0, v177
    v_add_f32 v178, 1.0, v178
    v_add_f32 v179, 1.0, v179
    v_add_f32 v180, 1.0, v180
    v_add_f32 v181, 1.0, v181
    v_add_f32 v182, 1.0, v182
    v_add_f32 v183, 1.0, v183
    v_mul_f32 v1, v72, v184
    v_mul_f32 v2, v73, v185
    v_mul_f32 v3, v74, v186
    v_mul_f32 v10, v75, v187
    v_mul_f32 v11, v76, v188
    v_mul_f32 v12, v77, v189
    v_mul_f32 v13, v78, v190
    v_mul_f32 v14, v79, v191
    v_fmaak_f32 v184, v88, v88, 0x409d30fc
    v_fmaak_f32 v185, v89, v89, 0x409d30fc
    v_fmaak_f32 v186, v90, v90, 0x409d30fc
    v_fmaak_f32 v187, v91, v91, 0x409d30fc
    v_fmaak_f32 v188, v92, v92, 0x409d30fc
    v_fmaak_f32 v189, v93, v93, 0x409d30fc
    v_fmaak_f32 v190, v94, v94, 0x409d30fc
    v_fmaak_f32 v191, v95, v95, 0x409d30fc
    v_mul_f32 v184, v88, v184
    v_mul_f32 v185, v89, v185
    v_mul_f32 v186, v90, v186
    v_mul_f32 v187, v91, v187
    v_mul_f32 v188, v92, v188
    v_mul_f32 v189, v93, v189
    v_mul_f32 v190, v94, v190
    v_mul_f32 v191, v95, v191
    s_setprio 2
    s_waitcnt lgkmcnt(0)
    v_mfma_f32_32x32x16_bf16 v[64:79], v[120:123], v[96:99], v[192:207]
    v_cvt_pk_bf16_f32 v172, v1, v2
    v_cvt_pk_bf16_f32 v173, v3, v10
    v_rcp_f32 v176, v176
    v_rcp_f32 v177, v177
    v_mfma_f32_32x32x16_bf16 v[64:79], v[124:127], v[100:103], v[64:79]
    v_cvt_pk_bf16_f32 v174, v11, v12
    v_cvt_pk_bf16_f32 v175, v13, v14
    v_rcp_f32 v178, v178
    v_rcp_f32 v179, v179
    v_mfma_f32_32x32x16_bf16 v[64:79], v[128:131], v[104:107], v[64:79]
    v_rcp_f32 v180, v180
    v_rcp_f32 v181, v181
    v_rcp_f32 v182, v182
    v_mfma_f32_32x32x16_bf16 v[64:79], v[132:135], v[108:111], v[64:79]
    v_rcp_f32 v183, v183
    v_exp_f32 v184, v184
    v_exp_f32 v185, v185
    v_mfma_f32_32x32x16_bf16 v[64:79], v[136:139], v[112:115], v[64:79]
    v_exp_f32 v186, v186
    v_exp_f32 v187, v187
    v_exp_f32 v188, v188
    v_mfma_f32_32x32x16_bf16 v[64:79], v[140:143], v[116:119], v[64:79]
    v_exp_f32 v189, v189
    v_exp_f32 v190, v190
    v_exp_f32 v191, v191
    v_readfirstlane_b32 s54, v0
    s_setprio 0
    s_add_u32 s54, s54, 0x77777777
    s_andn2_b32 s54, 0x80808080, s54
    s_cbranch_scc0 L_needH19_ok
L_needH19:
    ds_read_b32 v0, v15 offset:0
    s_waitcnt lgkmcnt(0)
    v_readfirstlane_b32 s54, v0
    s_nop 0
    s_add_u32 s54, s54, 0x77777777
    s_andn2_b32 s54, 0x80808080, s54
    s_cbranch_scc1 L_needH19
L_needH19_ok:
    ds_read_b64_tr_b16 v[144:145], v5 offset:39936
    ds_read_b64_tr_b16 v[146:147], v5 offset:41472
    ds_read_b64_tr_b16 v[148:149], v5 offset:40000
    ds_read_b64_tr_b16 v[150:151], v5 offset:41536
    ds_read_b64_tr_b16 v[152:153], v5 offset:40064
    ds_read_b64_tr_b16 v[154:155], v5 offset:41600
    ds_read_b64_tr_b16 v[156:157], v5 offset:12288
    ds_read_b64_tr_b16 v[158:159], v5 offset:13824
    ds_read_b64_tr_b16 v[160:161], v5 offset:12352
    ds_read_b64_tr_b16 v[162:163], v5 offset:13888
    ds_read_b64_tr_b16 v[164:165], v5 offset:12416
    ds_read_b64_tr_b16 v[166:167], v5 offset:13952
    v_add_f32 v184, 1.0, v184
    v_add_f32 v185, 1.0, v185
    v_add_f32 v186, 1.0, v186
    v_add_f32 v187, 1.0, v187
    v_add_f32 v188, 1.0, v188
    v_add_f32 v189, 1.0, v189
    v_add_f32 v190, 1.0, v190
    v_add_f32 v191, 1.0, v191
    v_mul_f32 v80, v80, v176
    v_mul_f32 v81, v81, v177
    v_mul_f32 v82, v82, v178
    v_mul_f32 v83, v83, v179
    v_mul_f32 v84, v84, v180
    v_mul_f32 v85, v85, v181
    v_mul_f32 v86, v86, v182
    v_mul_f32 v87, v87, v183
    v_fmaak_f32 v176, v64, v64, 0x409d30fc
    v_fmaak_f32 v177, v65, v65, 0x409d30fc
    v_fmaak_f32 v178, v66, v66, 0x409d30fc
    v_fmaak_f32 v179, v67, v67, 0x409d30fc
    v_fmaak_f32 v180, v68, v68, 0x409d30fc
    v_fmaak_f32 v181, v69, v69, 0x409d30fc
    v_fmaak_f32 v182, v70, v70, 0x409d30fc
    v_fmaak_f32 v183, v71, v71, 0x409d30fc
    v_mul_f32 v176, v64, v176
    v_mul_f32 v177, v65, v177
    v_mul_f32 v178, v66, v178
    v_mul_f32 v179, v67, v179
    v_mul_f32 v180, v68, v180
    v_mul_f32 v181, v69, v181
    v_mul_f32 v182, v70, v182
    v_mul_f32 v183, v71, v183
    v_add_u32 v8, 73728, v9
    s_setprio 2
    s_waitcnt lgkmcnt(0)
    v_mfma_f32_32x32x16_bf16 v[208:223], v[144:147], v[172:175], v[208:223]
    v_cvt_pk_bf16_f32 v168, v80, v81
    v_cvt_pk_bf16_f32 v169, v82, v83
    v_rcp_f32 v184, v184
    v_rcp_f32 v185, v185
    v_mfma_f32_32x32x16_bf16 v[224:239], v[148:151], v[172:175], v[224:239]
    v_cvt_pk_bf16_f32 v170, v84, v85
    v_cvt_pk_bf16_f32 v171, v86, v87
    v_rcp_f32 v186, v186
    v_rcp_f32 v187, v187
    v_mfma_f32_32x32x16_bf16 v[240:255], v[152:155], v[172:175], v[240:255]
    v_rcp_f32 v188, v188
    v_rcp_f32 v189, v189
    v_rcp_f32 v190, v190
    v_mfma_f32_32x32x16_bf16 v[16:31], v[156:159], v[168:171], 0
    v_rcp_f32 v191, v191
    v_exp_f32 v176, v176
    v_exp_f32 v177, v177
    v_mfma_f32_32x32x16_bf16 v[32:47], v[160:163], v[168:171], 0
    v_exp_f32 v178, v178
    v_exp_f32 v179, v179
    v_exp_f32 v180, v180
    v_mfma_f32_32x32x16_bf16 v[48:63], v[164:167], v[168:171], 0
    v_exp_f32 v181, v181
    v_exp_f32 v182, v182
    v_exp_f32 v183, v183
    s_setprio 0
    ds_read_b128 v[192:195], v6 offset:256
    ds_read_b128 v[196:199], v6 offset:288
    ds_read_b128 v[200:203], v6 offset:320
    ds_read_b128 v[204:207], v6 offset:352
    ds_read_b64_tr_b16 v[120:121], v4 offset:24576
    ds_read_b64_tr_b16 v[122:123], v4 offset:25600
    ds_read_b64_tr_b16 v[124:125], v4 offset:26624
    ds_read_b64_tr_b16 v[126:127], v4 offset:27648
    ds_read_b64_tr_b16 v[128:129], v4 offset:28672
    ds_read_b64_tr_b16 v[130:131], v4 offset:29696
    ds_read_b64_tr_b16 v[132:133], v4 offset:30720
    ds_read_b64_tr_b16 v[134:135], v4 offset:31744
    ds_read_b64_tr_b16 v[136:137], v4 offset:32768
    ds_read_b64_tr_b16 v[138:139], v4 offset:33792
    ds_read_b64_tr_b16 v[140:141], v4 offset:34816
    ds_read_b64_tr_b16 v[142:143], v4 offset:35840
    ds_write_b128 v8, v[208:211] offset:0
    ds_write_b128 v8, v[212:215] offset:1024
    ds_write_b128 v8, v[216:219] offset:2048
    ds_write_b128 v8, v[220:223] offset:3072
    v_add_f32 v176, 1.0, v176
    v_add_f32 v177, 1.0, v177
    v_add_f32 v178, 1.0, v178
    v_add_f32 v179, 1.0, v179
    v_add_f32 v180, 1.0, v180
    v_add_f32 v181, 1.0, v181
    v_add_f32 v182, 1.0, v182
    v_add_f32 v183, 1.0, v183
    v_mul_f32 v1, v88, v184
    v_mul_f32 v2, v89, v185
    v_mul_f32 v3, v90, v186
    v_mul_f32 v10, v91, v187
    v_mul_f32 v11, v92, v188
    v_mul_f32 v12, v93, v189
    v_mul_f32 v13, v94, v190
    v_mul_f32 v14, v95, v191
    v_fmaak_f32 v184, v72, v72, 0x409d30fc
    v_fmaak_f32 v185, v73, v73, 0x409d30fc
    v_fmaak_f32 v186, v74, v74, 0x409d30fc
    v_fmaak_f32 v187, v75, v75, 0x409d30fc
    v_fmaak_f32 v188, v76, v76, 0x409d30fc
    v_fmaak_f32 v189, v77, v77, 0x409d30fc
    v_fmaak_f32 v190, v78, v78, 0x409d30fc
    v_fmaak_f32 v191, v79, v79, 0x409d30fc
    v_mul_f32 v184, v72, v184
    v_mul_f32 v185, v73, v185
    v_mul_f32 v186, v74, v186
    v_mul_f32 v187, v75, v187
    v_mul_f32 v188, v76, v188
    v_mul_f32 v189, v77, v189
    v_mul_f32 v190, v78, v190
    v_mul_f32 v191, v79, v191
    s_setprio 2
    s_waitcnt lgkmcnt(0)
    v_mfma_f32_32x32x16_bf16 v[80:95], v[120:123], v[96:99], v[192:207]
    v_cvt_pk_bf16_f32 v172, v1, v2
    v_cvt_pk_bf16_f32 v173, v3, v10
    v_rcp_f32 v176, v176
    v_rcp_f32 v177, v177
    v_mfma_f32_32x32x16_bf16 v[80:95], v[124:127], v[100:103], v[80:95]
    v_cvt_pk_bf16_f32 v174, v11, v12
    v_cvt_pk_bf16_f32 v175, v13, v14
    v_rcp_f32 v178, v178
    v_rcp_f32 v179, v179
    v_mfma_f32_32x32x16_bf16 v[80:95], v[128:131], v[104:107], v[80:95]
    v_rcp_f32 v180, v180
    v_rcp_f32 v181, v181
    v_rcp_f32 v182, v182
    v_mfma_f32_32x32x16_bf16 v[80:95], v[132:135], v[108:111], v[80:95]
    v_rcp_f32 v183, v183
    v_exp_f32 v184, v184
    v_exp_f32 v185, v185
    v_mfma_f32_32x32x16_bf16 v[80:95], v[136:139], v[112:115], v[80:95]
    v_exp_f32 v186, v186
    v_exp_f32 v187, v187
    v_exp_f32 v188, v188
    v_mfma_f32_32x32x16_bf16 v[80:95], v[140:143], v[116:119], v[80:95]
    v_exp_f32 v189, v189
    v_exp_f32 v190, v190
    v_exp_f32 v191, v191
    s_setprio 0
    ds_read_b64_tr_b16 v[144:145], v5 offset:15360
    ds_read_b64_tr_b16 v[146:147], v5 offset:16896
    ds_read_b64_tr_b16 v[148:149], v5 offset:15424
    ds_read_b64_tr_b16 v[150:151], v5 offset:16960
    ds_read_b64_tr_b16 v[152:153], v5 offset:15488
    ds_read_b64_tr_b16 v[154:155], v5 offset:17024
    ds_read_b64_tr_b16 v[156:157], v5 offset:18432
    ds_read_b64_tr_b16 v[158:159], v5 offset:19968
    ds_read_b64_tr_b16 v[160:161], v5 offset:18496
    ds_read_b64_tr_b16 v[162:163], v5 offset:20032
    ds_read_b64_tr_b16 v[164:165], v5 offset:18560
    ds_read_b64_tr_b16 v[166:167], v5 offset:20096
    ds_write_b128 v8, v[224:227] offset:4096
    ds_write_b128 v8, v[228:231] offset:5120
    ds_write_b128 v8, v[232:235] offset:6144
    ds_write_b128 v8, v[236:239] offset:7168
    v_add_f32 v184, 1.0, v184
    v_add_f32 v185, 1.0, v185
    v_add_f32 v186, 1.0, v186
    v_add_f32 v187, 1.0, v187
    v_add_f32 v188, 1.0, v188
    v_add_f32 v189, 1.0, v189
    v_add_f32 v190, 1.0, v190
    v_add_f32 v191, 1.0, v191
    v_mul_f32 v64, v64, v176
    v_mul_f32 v65, v65, v177
    v_mul_f32 v66, v66, v178
    v_mul_f32 v67, v67, v179
    v_mul_f32 v68, v68, v180
    v_mul_f32 v69, v69, v181
    v_mul_f32 v70, v70, v182
    v_mul_f32 v71, v71, v183
    v_fmaak_f32 v176, v80, v80, 0x409d30fc
    v_fmaak_f32 v177, v81, v81, 0x409d30fc
    v_fmaak_f32 v178, v82, v82, 0x409d30fc
    v_fmaak_f32 v179, v83, v83, 0x409d30fc
    v_fmaak_f32 v180, v84, v84, 0x409d30fc
    v_fmaak_f32 v181, v85, v85, 0x409d30fc
    v_fmaak_f32 v182, v86, v86, 0x409d30fc
    v_fmaak_f32 v183, v87, v87, 0x409d30fc
    v_mul_f32 v176, v80, v176
    v_mul_f32 v177, v81, v177
    v_mul_f32 v178, v82, v178
    v_mul_f32 v179, v83, v179
    v_mul_f32 v180, v84, v180
    v_mul_f32 v181, v85, v181
    v_mul_f32 v182, v86, v182
    v_mul_f32 v183, v87, v183
    v_mov_b32 v0, 2
    s_setprio 2
    s_waitcnt lgkmcnt(0)
    v_mfma_f32_32x32x16_bf16 v[16:31], v[144:147], v[172:175], v[16:31]
    v_cvt_pk_bf16_f32 v168, v64, v65
    v_cvt_pk_bf16_f32 v169, v66, v67
    v_rcp_f32 v184, v184
    v_rcp_f32 v185, v185
    v_mfma_f32_32x32x16_bf16 v[32:47], v[148:151], v[172:175], v[32:47]
    v_cvt_pk_bf16_f32 v170, v68, v69
    v_cvt_pk_bf16_f32 v171, v70, v71
    v_rcp_f32 v186, v186
    v_rcp_f32 v187, v187
    v_mfma_f32_32x32x16_bf16 v[48:63], v[152:155], v[172:175], v[48:63]
    v_rcp_f32 v188, v188
    v_rcp_f32 v189, v189
    v_rcp_f32 v190, v190
    v_mfma_f32_32x32x16_bf16 v[16:31], v[156:159], v[168:171], v[16:31]
    v_rcp_f32 v191, v191
    v_exp_f32 v176, v176
    v_exp_f32 v177, v177
    v_mfma_f32_32x32x16_bf16 v[32:47], v[160:163], v[168:171], v[32:47]
    v_exp_f32 v178, v178
    v_exp_f32 v179, v179
    v_exp_f32 v180, v180
    v_mfma_f32_32x32x16_bf16 v[48:63], v[164:167], v[168:171], v[48:63]
    v_exp_f32 v181, v181
    v_exp_f32 v182, v182
    v_exp_f32 v183, v183
    s_setprio 0
    ds_read_b64_tr_b16 v[120:121], v5 offset:21504
    ds_read_b64_tr_b16 v[122:123], v5 offset:23040
    ds_read_b64_tr_b16 v[124:125], v5 offset:21568
    ds_read_b64_tr_b16 v[126:127], v5 offset:23104
    ds_read_b64_tr_b16 v[128:129], v5 offset:21632
    ds_read_b64_tr_b16 v[130:131], v5 offset:23168
    ds_write_b128 v8, v[240:243] offset:8192
    ds_write_b128 v8, v[244:247] offset:9216
    ds_write_b128 v8, v[248:251] offset:10240
    ds_write_b128 v8, v[252:255] offset:11264
    ds_write_b8 v15, v0 offset:11
    v_add_f32 v176, 1.0, v176
    v_add_f32 v177, 1.0, v177
    v_add_f32 v178, 1.0, v178
    v_add_f32 v179, 1.0, v179
    v_add_f32 v180, 1.0, v180
    v_add_f32 v181, 1.0, v181
    v_add_f32 v182, 1.0, v182
    v_add_f32 v183, 1.0, v183
    v_mul_f32 v72, v72, v184
    v_mul_f32 v73, v73, v185
    v_mul_f32 v74, v74, v186
    v_mul_f32 v75, v75, v187
    v_mul_f32 v76, v76, v188
    v_mul_f32 v77, v77, v189
    v_mul_f32 v78, v78, v190
    v_mul_f32 v79, v79, v191
    v_fmaak_f32 v184, v88, v88, 0x409d30fc
    v_fmaak_f32 v185, v89, v89, 0x409d30fc
    v_fmaak_f32 v186, v90, v90, 0x409d30fc
    v_fmaak_f32 v187, v91, v91, 0x409d30fc
    v_fmaak_f32 v188, v92, v92, 0x409d30fc
    v_fmaak_f32 v189, v93, v93, 0x409d30fc
    v_fmaak_f32 v190, v94, v94, 0x409d30fc
    v_fmaak_f32 v191, v95, v95, 0x409d30fc
    v_mul_f32 v184, v88, v184
    v_mul_f32 v185, v89, v185
    v_mul_f32 v186, v90, v186
    v_mul_f32 v187, v91, v187
    v_mul_f32 v188, v92, v188
    v_mul_f32 v189, v93, v189
    v_mul_f32 v190, v94, v190
    v_mul_f32 v191, v95, v191
    s_setprio 2
    s_waitcnt lgkmcnt(0)
    v_cvt_pk_bf16_f32 v172, v72, v73
    v_cvt_pk_bf16_f32 v173, v74, v75
    v_cvt_pk_bf16_f32 v174, v76, v77
    v_cvt_pk_bf16_f32 v175, v78, v79
    v_rcp_f32 v176, v176
    v_rcp_f32 v177, v177
    v_mfma_f32_32x32x16_bf16 v[16:31], v[120:123], v[172:175], v[16:31]
    v_rcp_f32 v178, v178
    v_rcp_f32 v179, v179
    v_rcp_f32 v180, v180
    v_mfma_f32_32x32x16_bf16 v[32:47], v[124:127], v[172:175], v[32:47]
    v_rcp_f32 v181, v181
    v_rcp_f32 v182, v182
    v_rcp_f32 v183, v183
    v_mfma_f32_32x32x16_bf16 v[48:63], v[128:131], v[172:175], v[48:63]
    v_exp_f32 v184, v184
    v_exp_f32 v185, v185
    v_exp_f32 v186, v186
    v_exp_f32 v187, v187
    v_exp_f32 v188, v188
    v_exp_f32 v189, v189
    v_exp_f32 v190, v190
    v_exp_f32 v191, v191
    s_setprio 0
    ds_read_b64_tr_b16 v[156:157], v5 offset:36864
    ds_read_b64_tr_b16 v[158:159], v5 offset:38400
    ds_read_b64_tr_b16 v[160:161], v5 offset:36928
    ds_read_b64_tr_b16 v[162:163], v5 offset:38464
    ds_read_b64_tr_b16 v[164:165], v5 offset:36992
    ds_read_b64_tr_b16 v[166:167], v5 offset:38528
    v_add_f32 v184, 1.0, v184
    v_add_f32 v185, 1.0, v185
    v_add_f32 v186, 1.0, v186
    v_add_f32 v187, 1.0, v187
    v_add_f32 v188, 1.0, v188
    v_add_f32 v189, 1.0, v189
    v_add_f32 v190, 1.0, v190
    v_add_f32 v191, 1.0, v191
    v_mul_f32 v80, v80, v176
    v_mul_f32 v81, v81, v177
    v_mul_f32 v82, v82, v178
    v_mul_f32 v83, v83, v179
    v_mul_f32 v84, v84, v180
    v_mul_f32 v85, v85, v181
    v_mul_f32 v86, v86, v182
    v_mul_f32 v87, v87, v183
    s_setprio 2
    s_waitcnt lgkmcnt(0)
    v_cvt_pk_bf16_f32 v168, v80, v81
    v_cvt_pk_bf16_f32 v169, v82, v83
    v_cvt_pk_bf16_f32 v170, v84, v85
    v_cvt_pk_bf16_f32 v171, v86, v87
    v_rcp_f32 v184, v184
    v_rcp_f32 v185, v185
    v_mfma_f32_32x32x16_bf16 v[16:31], v[156:159], v[168:171], v[16:31]
    v_rcp_f32 v186, v186
    v_rcp_f32 v187, v187
    v_rcp_f32 v188, v188
    v_mfma_f32_32x32x16_bf16 v[32:47], v[160:163], v[168:171], v[32:47]
    v_rcp_f32 v189, v189
    v_rcp_f32 v190, v190
    v_rcp_f32 v191, v191
    v_mfma_f32_32x32x16_bf16 v[48:63], v[164:167], v[168:171], v[48:63]
    s_setprio 0
    ds_read_b64_tr_b16 v[132:133], v5 offset:39936
    ds_read_b64_tr_b16 v[134:135], v5 offset:41472
    ds_read_b64_tr_b16 v[136:137], v5 offset:40000
    ds_read_b64_tr_b16 v[138:139], v5 offset:41536
    ds_read_b64_tr_b16 v[140:141], v5 offset:40064
    ds_read_b64_tr_b16 v[142:143], v5 offset:41600
    v_mul_f32 v88, v88, v184
    v_mul_f32 v89, v89, v185
    v_mul_f32 v90, v90, v186
    v_mul_f32 v91, v91, v187
    v_mul_f32 v92, v92, v188
    v_mul_f32 v93, v93, v189
    v_mul_f32 v94, v94, v190
    v_mul_f32 v95, v95, v191
    s_setprio 2
    s_waitcnt lgkmcnt(0)
    v_cvt_pk_bf16_f32 v172, v88, v89
    v_cvt_pk_bf16_f32 v173, v90, v91
    v_cvt_pk_bf16_f32 v174, v92, v93
    v_cvt_pk_bf16_f32 v175, v94, v95
    v_add_u32 v8, 147456, v9
    v_mov_b32 v0, 3
    v_mfma_f32_32x32x16_bf16 v[16:31], v[132:135], v[172:175], v[16:31]
    v_mfma_f32_32x32x16_bf16 v[32:47], v[136:139], v[172:175], v[32:47]
    v_mfma_f32_32x32x16_bf16 v[48:63], v[140:143], v[172:175], v[48:63]
    s_nop 9
    ds_write_b128 v8, v[16:19] offset:0
    ds_write_b128 v8, v[20:23] offset:1024
    ds_write_b128 v8, v[24:27] offset:2048
    ds_write_b128 v8, v[28:31] offset:3072
    ds_write_b128 v8, v[32:35] offset:4096
    ds_write_b128 v8, v[36:39] offset:5120
    ds_write_b128 v8, v[40:43] offset:6144
    ds_write_b128 v8, v[44:47] offset:7168
    ds_write_b128 v8, v[48:51] offset:8192
    ds_write_b128 v8, v[52:55] offset:9216
    ds_write_b128 v8, v[56:59] offset:10240
    ds_write_b128 v8, v[60:63] offset:11264
    ds_write_b8 v15, v0 offset:11
L_end:
    s_endpgm
L_codeend:
.section .rodata,"a"
.p2align 6
.amdhsa_kernel standalone__modern_conv_block_convnext__vision_kernel
  .amdhsa_next_free_vgpr 256
  .amdhsa_next_free_sgpr 102
  .amdhsa_accum_offset 256
  .amdhsa_group_segment_fixed_size 0
  .amdhsa_kernarg_size 80
  .amdhsa_user_sgpr_count 2
  .amdhsa_user_sgpr_kernarg_segment_ptr 1
  .amdhsa_system_sgpr_workgroup_id_x 1
.end_amdhsa_kernel
```
